```python
import torch

def _softmax(x, axis=-1):
    return torch.softmax(x, dim=axis)
def _gelu(x):
    return torch.nn.functional.gelu(x, approximate="tanh")
def _silu(x):
    return torch.nn.functional.silu(x)
def _sigmoid(x):
    return torch.sigmoid(x)
def _layernorm(x, axis=-1, eps=1e-5):
    m = x.mean(dim=axis, keepdim=True)
    v = x.var(dim=axis, keepdim=True, unbiased=False)
    return (x - m) / torch.sqrt(v + eps)
def _scatter_add(tgt, idx, src, axis=0):
    return tgt.clone().index_add_(axis, idx, src)
def _segment_sum(src, seg, n):
    out = torch.zeros((n,) + src.shape[1:], dtype=src.dtype)
    return out.index_add_(0, seg, src)
def _pad(x, pw):
    flat = tuple(v for pair in reversed(pw) for v in pair)
    return torch.nn.functional.pad(x, flat)

kernel_name = 'recurrent_scan__sliding_block_cached__geglu_ffn__decode'

def setup_inputs():

    _w = (lambda a: (lambda t: t.to(torch.bfloat16) if t.is_floating_point() else t)(torch.as_tensor(a)))
    def _A_setup():
        B, Sq, D = 1, 1, 512
        Hq, Hkv, Sk, Dh = 32, 32, 32768, 128
        assert Hq % Hkv == 0, (Hq, Hkv)
        return {
            "x": _w((lambda *s: torch.randn(*s, dtype=torch.bfloat16) * 0.05)(B, Sq, D)),
            "k_cache": _w((lambda *s: torch.randn(*s, dtype=torch.bfloat16) * 1.6)(B, Hkv, Sk, Dh)),
            "v_cache": _w((lambda *s: torch.randn(*s, dtype=torch.bfloat16) * 0.2)(B, Hkv, Sk, Dh)),
            "wq": _w((lambda *s: torch.randn(*s, dtype=torch.bfloat16) * 1.6)(D, Hq * Dh) * (D ** -0.5)),
            "wo": _w((lambda *s: torch.randn(*s, dtype=torch.bfloat16) * 0.2)(Hq * Dh, D) * ((Hq * Dh) ** -0.5)),
        }
    _A_in = _A_setup()

    def _B_setup():
        B, S, D, F = 1, 1, 512, 1376
        return {
            "x": _w((lambda *s: torch.randn(*s, dtype=torch.bfloat16) * 0.05)(B, S, D)),
            "w_gate": _w((lambda *s: torch.randn(*s, dtype=torch.bfloat16) * 0.1)(D, F)),
            "w_up": _w((lambda *s: torch.randn(*s, dtype=torch.bfloat16) * 0.1)(D, F)),
            "w_down": _w((lambda *s: torch.randn(*s, dtype=torch.bfloat16) * 0.1)(F, D)),
        }
    _B_in = _B_setup()

    return {
        "A_x": _A_in["x"],
        "A_k_cache": _A_in["k_cache"],
        "A_v_cache": _A_in["v_cache"],
        "A_wq": _A_in["wq"],
        "A_wo": _A_in["wo"],
        "B_x": _B_in["x"],
        "B_w_gate": _B_in["w_gate"],
        "B_w_up": _B_in["w_up"],
        "B_w_down": _B_in["w_down"],
    }

def reference(A_x, A_k_cache, A_v_cache, A_wq, A_wo, B_x, B_w_gate, B_w_up, B_w_down):
    def _A_ref(x, k_cache, v_cache, wq, wo):
        B, Sq, D = x.shape
        Hq, Dh = 32, 128
        Hkv, Sk = k_cache.shape[1], k_cache.shape[2]
        W = min(4096, max(256, Sk // 4))
        rep = Hq // Hkv
        q = (lambda x, *d: x.permute(*d))((x @ wq).reshape(B, Sq, Hq, Dh), 0, 2, 1, 3)
        k = (lambda x, n, axis: torch.repeat_interleave(x, n, dim=axis))(k_cache[:, :, Sk - W:, :], rep, axis=1)
        v = (lambda x, n, axis: torch.repeat_interleave(x, n, dim=axis))(v_cache[:, :, Sk - W:, :], rep, axis=1)
        scores = torch.einsum("bhqd,bhkd->bhqk", q, k) * (Dh ** -0.5)
        p = _softmax(scores, axis=-1)
        o = torch.einsum("bhqk,bhkd->bhqd", p, v)
        return (lambda x, *d: x.permute(*d))(o, 0, 2, 1, 3).reshape(B, Sq, Hq * Dh) @ wo

    def _B_ref(x, w_gate, w_up, w_down):
        return (_gelu(x @ w_gate) * (x @ w_up)) @ w_down

    x = A_x
    xn = _layernorm(x, axis=-1)
    s = _A_ref(xn, A_k_cache, A_v_cache, A_wq, A_wo)
    g = _silu(_B_ref(xn, B_w_gate, B_w_up, B_w_down))
    return x + s * g
```

```asm
; @launch grid=(256,1,1) block=(768,1,1) lds=65536
.amdgcn_target "amdgcn-amd-amdhsa--gfx950"
.text
.globl recurrent_scan__sliding_block_cached__geglu_ffn__decode_kernel
.p2align 8
.type recurrent_scan__sliding_block_cached__geglu_ffn__decode_kernel,@function
recurrent_scan__sliding_block_cached__geglu_ffn__decode_kernel:
    s_load_dwordx2 s[34:35], s[0:1], 8
    s_cmp_ge_u32 s2, 256
    s_cbranch_scc1 L_end
    v_lshrrev_b32 v1, 6, v0
    s_and_b32 s44, s2, 31
    s_lshr_b32 s45, s2, 5
    v_readfirstlane_b32 s3, v1
    v_and_b32 v2, 63, v0
    v_and_b32 v30, 7, v0
    v_mov_b32 v3, 0
    s_cmp_lt_u32 s3, 4
    s_cbranch_scc1 L_aux
    s_lshl_b32 s47, s44, 23
    s_lshl_b32 s48, s45, 17
    s_add_u32 s47, s47, s48
    s_add_u32 s49, s47, 0x700000
    s_sub_u32 s3, s3, 4
    v_lshlrev_b32 v1, 4, v0
    v_subrev_u32 v1, 4096, v1
    s_mov_b32 s30, 0x20000
    s_mov_b32 s31, 0x20000
    v_lshrrev_b32 v29, 3, v2
    v_lshlrev_b32 v28, 4, v30
    s_mul_i32 s47, s2, 0x9e3779b1
    s_lshr_b32 s47, s47, 28
    s_lshl_b32 s47, s47, 13
    s_waitcnt lgkmcnt(0)
    s_add_u32 s28, s34, s49
    s_addc_u32 s29, s35, 0
    buffer_load_dwordx4 v[32:35], v1, s[28:31], s47 offen offset:0 nt
    s_addk_i32 s47, 0x2000
    s_bitset0_b32 s47, 17
    buffer_load_dwordx4 v[36:39], v1, s[28:31], s47 offen offset:0 nt
    s_addk_i32 s47, 0x2000
    s_bitset0_b32 s47, 17
    buffer_load_dwordx4 v[40:43], v1, s[28:31], s47 offen offset:0 nt
    s_addk_i32 s47, 0x2000
    s_bitset0_b32 s47, 17
    buffer_load_dwordx4 v[44:47], v1, s[28:31], s47 offen offset:0 nt
    s_load_dwordx16 s[4:19], s[0:1], 0
    s_load_dwordx8 s[20:27], s[0:1], 64
    s_branch L_main2
L_aux:
    s_load_dwordx16 s[4:19], s[0:1], 0
    s_load_dwordx8 s[20:27], s[0:1], 64
    s_getpc_b64 s[50:51]
L_pc:
    s_lshr_b32 s52, s2, 3
    s_mul_i32 s52, s52, 3
    v_subrev_u32 v6, 192, v0
    v_cmp_gt_u32 vcc, 3, v6
    v_add_u32 v6, s52, v6
    v_min_u32 v6, (L_code_end-L_pc)/128, v6
    s_and_saveexec_b64 s[52:53], vcc
    s_cbranch_execz L_nopf
    v_lshlrev_b32 v6, 7, v6
    global_load_dword v31, v6, s[50:51]
L_nopf:
    s_mov_b64 exec, -1
    v_mov_b32 v4, -1
    v_lshlrev_b32 v15, 2, v30
    ds_write_b32 v15, v3 offset:256
    ds_write_b32 v15, v4 offset:288
    ds_write_b32 v15, v3 offset:320
    v_lshlrev_b32 v1, 4, v2
    v_and_b32 v10, 15, v2
    v_lshrrev_b32 v11, 4, v2
    v_bfe_u32 v13, v2, 3, 1
    s_waitcnt lgkmcnt(0)
    s_load_dword s46, s[26:27], 0
    s_cmp_gt_u32 s3, 1
    s_cbranch_scc1 L_nox
    global_load_dwordx4 v[4:7], v1, s[4:5]
L_nox:
    s_barrier
    s_branch L_aux2
L_main2:
    s_waitcnt lgkmcnt(0)
    s_load_dword s46, s[26:27], 0
    s_lshl_b32 s50, s3, 2
    v_mov_b32 v31, s50
    s_barrier
    s_lshr_b32 s48, s45, 1
    s_lshl_b32 s48, s48, 20
    s_lshl_b32 s50, s44, 8
    s_add_u32 s48, s48, s50
    s_and_b32 s50, s45, 1
    s_lshl_b32 s50, s50, 7
    s_add_u32 s48, s48, s50
    s_add_u32 s40, s10, s48
    s_addc_u32 s41, s11, 0
    s_mov_b32 s42, 1040512
    s_mov_b32 s43, 0x20000
    v_lshl_add_u32 v27, v29, 13, v28
    s_lshl_b32 s48, s3, 17
    s_lshl_b32 s33, s3, 11
    s_add_u32 m0, s33, 8192
    s_waitcnt vmcnt(3)
    buffer_load_dwordx4 v27, s[40:43], s48 offen nt lds
    s_add_u32 s48, s48, 0x10000
    s_add_u32 m0, s33, 9216
    s_waitcnt vmcnt(3)
    buffer_load_dwordx4 v27, s[40:43], s48 offen nt lds
    s_and_b32 s50, s2, 7
    s_lshr_b32 s51, s2, 3
    s_mov_b32 s56, 0x120b0700
    s_mov_b32 s57, 0x28211d16
    s_lshl_b32 s53, s50, 3
    s_lshr_b64 s[56:57], s[56:57], s53
    s_and_b32 s56, s56, 0xff
    s_lshl_b32 s53, s50, 2
    s_lshr_b32 s57, 0x37474747, s53
    s_and_b32 s57, s57, 15
    s_and_b32 s53, s51, 3
    s_lshl_b32 s53, s53, 1
    s_lshr_b32 s54, s51, 4
    s_add_u32 s53, s53, s54
    s_lshr_b32 s54, s56, 1
    s_add_u32 s53, s53, s54
    s_add_u32 s58, s56, s57
    s_add_u32 s59, s58, 1
    s_lshr_b32 s59, s59, 1
    s_add_u32 s54, s56, 43
    s_lshr_b32 s54, s54, 1
    s_sub_u32 s54, s54, s59
    s_cmp_lt_u32 s53, s59
    s_cselect_b32 s54, 0, s54
    s_add_u32 s53, s53, s54
    s_add_u32 s59, s58, 44
    s_lshr_b32 s59, s59, 1
    s_cmp_ge_u32 s53, s59
    s_cbranch_scc1 L_skipA
    s_mov_b32 s42, 346880
    s_bfe_u32 s48, s51, 0x20002
    s_mul_i32 s48, s48, 352256
    s_lshl_b32 s53, s53, 7
    s_add_u32 s59, s48, s53
    s_add_u32 s40, s16, s59
    s_addc_u32 s41, s17, 0
    v_mul_u32_u24 v27, 5504, v29
    v_add_u32 v27, v27, v28
    s_mul_i32 s48, s3, 44032
    s_add_u32 m0, s33, 24576
    s_waitcnt vmcnt(3)
    buffer_load_dwordx4 v27, s[40:43], s48 offen nt lds
    s_add_u32 s40, s18, s59
    s_addc_u32 s41, s19, 0
    s_add_u32 m0, s33, 25600
    s_waitcnt vmcnt(3)
    buffer_load_dwordx4 v27, s[40:43], s48 offen nt lds
L_skipA:
    s_mov_b32 s36, s26
    s_mov_b32 s37, s27
    s_mov_b32 s38, 1048576
    s_mov_b32 s39, 0x20000
    v_mov_b32 v8, 0
    v_mov_b32 v9, 0
    v_mov_b32 v10, 0
    v_mov_b32 v11, 0
    v_mov_b32 v12, 0
    v_mov_b32 v13, 0
    v_mov_b32 v14, 0
    v_mov_b32 v15, 0
    v_mov_b32 v16, 0
    v_mov_b32 v17, 0
    v_mov_b32 v18, 0
    v_mov_b32 v19, 0
    v_mov_b32 v20, 0
    v_mov_b32 v21, 0
    v_mov_b32 v22, 0
    v_mov_b32 v23, 0
    v_and_b32 v24, 1, v2
    v_cmp_eq_u32 vcc, 1, v24
    v_mov_b32 v24, 0xffff
    v_mov_b32 v25, 0xffff0000
    v_cndmask_b32 v24, v24, v25, vcc
    v_bfe_u32 v25, v2, 1, 2
    v_cmp_eq_u32 vcc, 0, v25
    s_nop 1
    v_cndmask_b32 v160, 0, v24, vcc
    v_cmp_eq_u32 vcc, 1, v25
    s_nop 1
    v_cndmask_b32 v161, 0, v24, vcc
    v_cmp_eq_u32 vcc, 2, v25
    s_nop 1
    v_cndmask_b32 v162, 0, v24, vcc
    v_cmp_eq_u32 vcc, 3, v25
    s_nop 1
    v_cndmask_b32 v163, 0, v24, vcc
    s_addk_i32 s47, 0x2000
    s_bitset0_b32 s47, 17
    s_waitcnt vmcnt(3)
    buffer_load_dwordx4 v[48:51], v1, s[28:31], s47 offen offset:0 nt
    s_addk_i32 s47, 0x2000
    s_bitset0_b32 s47, 17
    s_waitcnt vmcnt(3)
    buffer_load_dwordx4 v[52:55], v1, s[28:31], s47 offen offset:0 nt
    s_addk_i32 s47, 0x2000
    s_bitset0_b32 s47, 17
    s_waitcnt vmcnt(3)
    buffer_load_dwordx4 v[56:59], v1, s[28:31], s47 offen offset:0 nt
    s_addk_i32 s47, 0x2000
    s_bitset0_b32 s47, 17
    s_waitcnt vmcnt(3)
    buffer_load_dwordx4 v[60:63], v1, s[28:31], s47 offen offset:0 nt
    v_mov_b32 v25, 2
    ds_write_b32 v31, v25 offset:320
    s_addk_i32 s47, 0x2000
    s_bitset0_b32 s47, 17
    s_waitcnt vmcnt(3)
    buffer_load_dwordx4 v[64:67], v1, s[28:31], s47 offen offset:0 nt
    s_addk_i32 s47, 0x2000
    s_bitset0_b32 s47, 17
    s_waitcnt vmcnt(3)
    buffer_load_dwordx4 v[68:71], v1, s[28:31], s47 offen offset:0 nt
    v_mov_b32 v25, 3
    ds_write_b32 v31, v25 offset:320
    s_addk_i32 s47, 0x2000
    s_bitset0_b32 s47, 17
    s_waitcnt vmcnt(3)
    buffer_load_dwordx4 v[72:75], v1, s[28:31], s47 offen offset:0 nt
    s_addk_i32 s47, 0x2000
    s_bitset0_b32 s47, 17
    s_waitcnt vmcnt(3)
    buffer_load_dwordx4 v[76:79], v1, s[28:31], s47 offen offset:0 nt
    s_addk_i32 s47, 0x2000
    s_bitset0_b32 s47, 17
    s_waitcnt vmcnt(3)
    buffer_load_dwordx4 v[80:83], v1, s[28:31], s47 offen offset:0 nt
    s_addk_i32 s47, 0x2000
    s_bitset0_b32 s47, 17
    s_waitcnt vmcnt(3)
    buffer_load_dwordx4 v[84:87], v1, s[28:31], s47 offen offset:0 nt
    s_addk_i32 s47, 0x2000
    s_bitset0_b32 s47, 17
    s_waitcnt vmcnt(3)
    buffer_load_dwordx4 v[88:91], v1, s[28:31], s47 offen offset:0 nt
    s_addk_i32 s47, 0x2000
    s_bitset0_b32 s47, 17
    s_waitcnt vmcnt(3)
    buffer_load_dwordx4 v[92:95], v1, s[28:31], s47 offen offset:0 nt
    s_add_u32 s28, s8, s49
    s_addc_u32 s29, s9, 0
    s_addk_i32 s47, 0x2000
    s_bitset0_b32 s47, 17
    s_waitcnt vmcnt(3)
    buffer_load_dwordx4 v[96:99], v1, s[28:31], s47 offen offset:0 nt
    v_mov_b32 v25, 4
    ds_write_b32 v31, v25 offset:320
    s_addk_i32 s47, 0x2000
    s_bitset0_b32 s47, 17
    s_waitcnt vmcnt(3)
    buffer_load_dwordx4 v[100:103], v1, s[28:31], s47 offen offset:0 nt
    s_addk_i32 s47, 0x2000
    s_bitset0_b32 s47, 17
    s_waitcnt vmcnt(3)
    buffer_load_dwordx4 v[104:107], v1, s[28:31], s47 offen offset:0 nt
    s_addk_i32 s47, 0x2000
    s_bitset0_b32 s47, 17
    s_waitcnt vmcnt(3)
    buffer_load_dwordx4 v[108:111], v1, s[28:31], s47 offen offset:0 nt
    s_addk_i32 s47, 0x2000
    s_bitset0_b32 s47, 17
    s_waitcnt vmcnt(3)
    buffer_load_dwordx4 v[112:115], v1, s[28:31], s47 offen offset:0 nt
    s_addk_i32 s47, 0x2000
    s_bitset0_b32 s47, 17
    s_waitcnt vmcnt(3)
    buffer_load_dwordx4 v[116:119], v1, s[28:31], s47 offen offset:0 nt
    s_addk_i32 s47, 0x2000
    s_bitset0_b32 s47, 17
    s_waitcnt vmcnt(3)
    buffer_load_dwordx4 v[120:123], v1, s[28:31], s47 offen offset:0 nt
    s_addk_i32 s47, 0x2000
    s_bitset0_b32 s47, 17
    s_waitcnt vmcnt(3)
    buffer_load_dwordx4 v[124:127], v1, s[28:31], s47 offen offset:0 nt
    s_addk_i32 s47, 0x2000
    s_bitset0_b32 s47, 17
    s_waitcnt vmcnt(3)
    buffer_load_dwordx4 v[128:131], v1, s[28:31], s47 offen offset:0 nt
    s_addk_i32 s47, 0x2000
    s_bitset0_b32 s47, 17
    s_waitcnt vmcnt(3)
    buffer_load_dwordx4 v[132:135], v1, s[28:31], s47 offen offset:0 nt
    s_addk_i32 s47, 0x2000
    s_bitset0_b32 s47, 17
    buffer_load_dwordx4 v[136:139], v1, s[28:31], s47 offen offset:0 nt
    s_addk_i32 s47, 0x2000
    s_bitset0_b32 s47, 17
    buffer_load_dwordx4 v[140:143], v1, s[28:31], s47 offen offset:0 nt
    s_mov_b32 s52, 262144
L_lp1:
    ds_read_b32 v24, v3 offset:256
    s_waitcnt lgkmcnt(0)
    v_cmp_ne_u32 vcc, 1, v24
    s_cbranch_vccz L_lok2
    s_sub_u32 s52, s52, 1
    s_cbranch_scc0 L_lp1
    s_branch L_fail
L_lok2:
    s_mul_i32 s46, s46, 0x9e3779b1
    s_add_u32 s46, s46, 0x7f4a7c15
    v_and_b32 v24, 15, v2
    v_lshlrev_b32 v24, 4, v24
    ds_read_b128 v[4:7], v24 offset:0
    s_waitcnt lgkmcnt(0)
    v_dot2c_f32_bf16 v8, v32, v4
    v_dot2c_f32_bf16 v9, v36, v4
    v_dot2c_f32_bf16 v10, v40, v4
    v_dot2c_f32_bf16 v11, v44, v4
    v_dot2c_f32_bf16 v12, v48, v4
    v_dot2c_f32_bf16 v13, v52, v4
    v_dot2c_f32_bf16 v14, v56, v4
    v_dot2c_f32_bf16 v15, v60, v4
    v_dot2c_f32_bf16 v16, v64, v4
    v_dot2c_f32_bf16 v17, v68, v4
    v_dot2c_f32_bf16 v18, v72, v4
    v_dot2c_f32_bf16 v19, v76, v4
    v_dot2c_f32_bf16 v20, v80, v4
    v_dot2c_f32_bf16 v21, v84, v4
    v_dot2c_f32_bf16 v22, v88, v4
    v_dot2c_f32_bf16 v23, v92, v4
    v_dot2c_f32_bf16 v8, v33, v5
    v_dot2c_f32_bf16 v9, v37, v5
    v_dot2c_f32_bf16 v10, v41, v5
    v_dot2c_f32_bf16 v11, v45, v5
    v_dot2c_f32_bf16 v12, v49, v5
    v_dot2c_f32_bf16 v13, v53, v5
    v_dot2c_f32_bf16 v14, v57, v5
    v_dot2c_f32_bf16 v15, v61, v5
    v_dot2c_f32_bf16 v16, v65, v5
    v_dot2c_f32_bf16 v17, v69, v5
    v_dot2c_f32_bf16 v18, v73, v5
    v_dot2c_f32_bf16 v19, v77, v5
    v_dot2c_f32_bf16 v20, v81, v5
    v_dot2c_f32_bf16 v21, v85, v5
    v_dot2c_f32_bf16 v22, v89, v5
    v_dot2c_f32_bf16 v23, v93, v5
    v_dot2c_f32_bf16 v8, v34, v6
    v_dot2c_f32_bf16 v9, v38, v6
    v_dot2c_f32_bf16 v10, v42, v6
    v_dot2c_f32_bf16 v11, v46, v6
    v_dot2c_f32_bf16 v12, v50, v6
    v_dot2c_f32_bf16 v13, v54, v6
    v_dot2c_f32_bf16 v14, v58, v6
    v_dot2c_f32_bf16 v15, v62, v6
    v_dot2c_f32_bf16 v16, v66, v6
    v_dot2c_f32_bf16 v17, v70, v6
    v_dot2c_f32_bf16 v18, v74, v6
    v_dot2c_f32_bf16 v19, v78, v6
    v_dot2c_f32_bf16 v20, v82, v6
    v_dot2c_f32_bf16 v21, v86, v6
    v_dot2c_f32_bf16 v22, v90, v6
    v_dot2c_f32_bf16 v23, v94, v6
    v_dot2c_f32_bf16 v8, v35, v7
    v_dot2c_f32_bf16 v9, v39, v7
    v_dot2c_f32_bf16 v10, v43, v7
    v_dot2c_f32_bf16 v11, v47, v7
    v_dot2c_f32_bf16 v12, v51, v7
    v_dot2c_f32_bf16 v13, v55, v7
    v_dot2c_f32_bf16 v14, v59, v7
    v_dot2c_f32_bf16 v15, v63, v7
    v_dot2c_f32_bf16 v16, v67, v7
    v_dot2c_f32_bf16 v17, v71, v7
    v_dot2c_f32_bf16 v18, v75, v7
    v_dot2c_f32_bf16 v19, v79, v7
    v_dot2c_f32_bf16 v20, v83, v7
    v_dot2c_f32_bf16 v21, v87, v7
    v_dot2c_f32_bf16 v22, v91, v7
    v_dot2c_f32_bf16 v23, v95, v7
    s_nop 2
    v_add_f32_dpp v8, v8, v8 row_ror:8 row_mask:0xf bank_mask:0x3
    v_add_f32_dpp v9, v9, v9 row_ror:8 row_mask:0xf bank_mask:0x3
    v_add_f32_dpp v10, v10, v10 row_ror:8 row_mask:0xf bank_mask:0x3
    v_add_f32_dpp v11, v11, v11 row_ror:8 row_mask:0xf bank_mask:0x3
    v_add_f32_dpp v12, v12, v12 row_ror:8 row_mask:0xf bank_mask:0x3
    v_add_f32_dpp v13, v13, v13 row_ror:8 row_mask:0xf bank_mask:0x3
    v_add_f32_dpp v14, v14, v14 row_ror:8 row_mask:0xf bank_mask:0x3
    v_add_f32_dpp v15, v15, v15 row_ror:8 row_mask:0xf bank_mask:0x3
    v_add_f32_dpp v8, v16, v16 row_ror:8 row_mask:0xf bank_mask:0xc
    v_add_f32_dpp v9, v17, v17 row_ror:8 row_mask:0xf bank_mask:0xc
    v_add_f32_dpp v10, v18, v18 row_ror:8 row_mask:0xf bank_mask:0xc
    v_add_f32_dpp v11, v19, v19 row_ror:8 row_mask:0xf bank_mask:0xc
    v_add_f32_dpp v12, v20, v20 row_ror:8 row_mask:0xf bank_mask:0xc
    v_add_f32_dpp v13, v21, v21 row_ror:8 row_mask:0xf bank_mask:0xc
    v_add_f32_dpp v14, v22, v22 row_ror:8 row_mask:0xf bank_mask:0xc
    v_add_f32_dpp v15, v23, v23 row_ror:8 row_mask:0xf bank_mask:0xc
    v_add_f32_dpp v8, v8, v8 row_shl:4 row_mask:0xf bank_mask:0x5
    v_add_f32_dpp v9, v9, v9 row_shl:4 row_mask:0xf bank_mask:0x5
    v_add_f32_dpp v10, v10, v10 row_shl:4 row_mask:0xf bank_mask:0x5
    v_add_f32_dpp v11, v11, v11 row_shl:4 row_mask:0xf bank_mask:0x5
    v_add_f32_dpp v8, v12, v12 row_shr:4 row_mask:0xf bank_mask:0xa
    v_add_f32_dpp v9, v13, v13 row_shr:4 row_mask:0xf bank_mask:0xa
    v_add_f32_dpp v10, v14, v14 row_shr:4 row_mask:0xf bank_mask:0xa
    v_add_f32_dpp v11, v15, v15 row_shr:4 row_mask:0xf bank_mask:0xa
    s_mov_b32 s50, 0xcccccccc
    s_mov_b32 s51, 0xcccccccc
    v_add_f32_dpp v8, v8, v8 quad_perm:[2,3,0,1] row_mask:0xf bank_mask:0xf
    v_add_f32_dpp v9, v9, v9 quad_perm:[2,3,0,1] row_mask:0xf bank_mask:0xf
    v_add_f32_dpp v10, v10, v10 quad_perm:[2,3,0,1] row_mask:0xf bank_mask:0xf
    v_add_f32_dpp v11, v11, v11 quad_perm:[2,3,0,1] row_mask:0xf bank_mask:0xf
    v_cndmask_b32 v8, v8, v10, s[50:51]
    v_cndmask_b32 v9, v9, v11, s[50:51]
    s_mov_b32 s50, 0xaaaaaaaa
    s_mov_b32 s51, 0xaaaaaaaa
    v_add_f32_dpp v8, v8, v8 quad_perm:[1,0,3,2] row_mask:0xf bank_mask:0xf
    v_add_f32_dpp v9, v9, v9 quad_perm:[1,0,3,2] row_mask:0xf bank_mask:0xf
    v_cndmask_b32 v8, v8, v9, s[50:51]
    v_cvt_pk_bf16_f32 v8, v8, v8
    v_and_b32 v8, 0xffff0000, v8
    v_mul_f32 v8, 0x3db504f3, v8
    v_cvt_pk_bf16_f32 v8, v8, v8
    v_and_b32 v8, 0xffff0000, v8
    v_mov_b32 v24, v8
    s_nop 1
    v_max_f32_dpp v24, v24, v24 row_ror:8 row_mask:0xf bank_mask:0xf
    s_nop 1
    v_max_f32_dpp v24, v24, v24 row_ror:4 row_mask:0xf bank_mask:0xf
    s_nop 1
    v_max_f32_dpp v24, v24, v24 row_ror:2 row_mask:0xf bank_mask:0xf
    s_nop 1
    v_max_f32_dpp v24, v24, v24 row_ror:1 row_mask:0xf bank_mask:0xf
    v_mov_b32 v25, v24
    s_nop 1
    v_permlane16_swap_b32 v25, v24
    s_nop 0
    v_max_f32 v24, v24, v25
    v_mov_b32 v25, v24
    s_nop 1
    v_permlane32_swap_b32 v25, v24
    s_nop 0
    v_max_f32 v24, v24, v25
    ds_write_b32 v31, v24 offset:288
    v_sub_f32 v8, v8, v24
    v_mul_f32 v8, 0x3fb8aa3b, v8
    v_exp_f32 v8, v8
    s_nop 0
    v_mov_b32 v26, v8
    v_cvt_pk_bf16_f32 v28, v8, v8
    s_nop 1
    v_add_f32_dpp v26, v26, v26 row_ror:8 row_mask:0xf bank_mask:0xf
    s_nop 1
    v_add_f32_dpp v26, v26, v26 row_ror:4 row_mask:0xf bank_mask:0xf
    s_nop 1
    v_add_f32_dpp v26, v26, v26 row_ror:2 row_mask:0xf bank_mask:0xf
    s_nop 1
    v_add_f32_dpp v26, v26, v26 row_ror:1 row_mask:0xf bank_mask:0xf
    v_mov_b32 v25, v26
    s_nop 1
    v_permlane16_swap_b32 v25, v26
    s_nop 0
    v_add_f32 v26, v26, v25
    v_mov_b32 v25, v26
    s_nop 1
    v_permlane32_swap_b32 v25, v26
    s_nop 0
    v_add_f32 v26, v26, v25
    v_and_b32_dpp v32, v28, v160 row_newbcast:0 row_mask:0xf bank_mask:0xf
    v_and_b32_dpp v33, v28, v161 row_newbcast:0 row_mask:0xf bank_mask:0xf
    v_and_b32_dpp v34, v28, v162 row_newbcast:0 row_mask:0xf bank_mask:0xf
    v_and_b32_dpp v35, v28, v163 row_newbcast:0 row_mask:0xf bank_mask:0xf
    s_waitcnt vmcnt(11)
    s_nop 0
    v_mfma_f32_16x16x32_bf16 v[164:167], v[32:35], v[96:99], 0
    v_and_b32_dpp v36, v28, v160 row_newbcast:1 row_mask:0xf bank_mask:0xf
    v_and_b32_dpp v37, v28, v161 row_newbcast:1 row_mask:0xf bank_mask:0xf
    v_and_b32_dpp v38, v28, v162 row_newbcast:1 row_mask:0xf bank_mask:0xf
    v_and_b32_dpp v39, v28, v163 row_newbcast:1 row_mask:0xf bank_mask:0xf
    s_waitcnt vmcnt(10)
    s_nop 0
    v_mfma_f32_16x16x32_bf16 v[164:167], v[36:39], v[100:103], v[164:167]
    v_and_b32_dpp v32, v28, v160 row_newbcast:2 row_mask:0xf bank_mask:0xf
    v_and_b32_dpp v33, v28, v161 row_newbcast:2 row_mask:0xf bank_mask:0xf
    v_and_b32_dpp v34, v28, v162 row_newbcast:2 row_mask:0xf bank_mask:0xf
    v_and_b32_dpp v35, v28, v163 row_newbcast:2 row_mask:0xf bank_mask:0xf
    s_waitcnt vmcnt(9)
    s_nop 0
    v_mfma_f32_16x16x32_bf16 v[164:167], v[32:35], v[104:107], v[164:167]
    v_and_b32_dpp v36, v28, v160 row_newbcast:3 row_mask:0xf bank_mask:0xf
    v_and_b32_dpp v37, v28, v161 row_newbcast:3 row_mask:0xf bank_mask:0xf
    v_and_b32_dpp v38, v28, v162 row_newbcast:3 row_mask:0xf bank_mask:0xf
    v_and_b32_dpp v39, v28, v163 row_newbcast:3 row_mask:0xf bank_mask:0xf
    s_waitcnt vmcnt(8)
    s_nop 0
    v_mfma_f32_16x16x32_bf16 v[164:167], v[36:39], v[108:111], v[164:167]
    v_and_b32_dpp v32, v28, v160 row_newbcast:4 row_mask:0xf bank_mask:0xf
    v_and_b32_dpp v33, v28, v161 row_newbcast:4 row_mask:0xf bank_mask:0xf
    v_and_b32_dpp v34, v28, v162 row_newbcast:4 row_mask:0xf bank_mask:0xf
    v_and_b32_dpp v35, v28, v163 row_newbcast:4 row_mask:0xf bank_mask:0xf
    s_waitcnt vmcnt(7)
    s_nop 0
    v_mfma_f32_16x16x32_bf16 v[164:167], v[32:35], v[112:115], v[164:167]
    v_and_b32_dpp v36, v28, v160 row_newbcast:5 row_mask:0xf bank_mask:0xf
    v_and_b32_dpp v37, v28, v161 row_newbcast:5 row_mask:0xf bank_mask:0xf
    v_and_b32_dpp v38, v28, v162 row_newbcast:5 row_mask:0xf bank_mask:0xf
    v_and_b32_dpp v39, v28, v163 row_newbcast:5 row_mask:0xf bank_mask:0xf
    s_waitcnt vmcnt(6)
    s_nop 0
    v_mfma_f32_16x16x32_bf16 v[164:167], v[36:39], v[116:119], v[164:167]
    v_and_b32_dpp v32, v28, v160 row_newbcast:6 row_mask:0xf bank_mask:0xf
    v_and_b32_dpp v33, v28, v161 row_newbcast:6 row_mask:0xf bank_mask:0xf
    v_and_b32_dpp v34, v28, v162 row_newbcast:6 row_mask:0xf bank_mask:0xf
    v_and_b32_dpp v35, v28, v163 row_newbcast:6 row_mask:0xf bank_mask:0xf
    s_waitcnt vmcnt(5)
    s_nop 0
    v_mfma_f32_16x16x32_bf16 v[164:167], v[32:35], v[120:123], v[164:167]
    v_and_b32_dpp v36, v28, v160 row_newbcast:7 row_mask:0xf bank_mask:0xf
    v_and_b32_dpp v37, v28, v161 row_newbcast:7 row_mask:0xf bank_mask:0xf
    v_and_b32_dpp v38, v28, v162 row_newbcast:7 row_mask:0xf bank_mask:0xf
    v_and_b32_dpp v39, v28, v163 row_newbcast:7 row_mask:0xf bank_mask:0xf
    s_waitcnt vmcnt(4)
    s_nop 0
    v_mfma_f32_16x16x32_bf16 v[164:167], v[36:39], v[124:127], v[164:167]
    v_and_b32_dpp v32, v28, v160 row_newbcast:8 row_mask:0xf bank_mask:0xf
    v_and_b32_dpp v33, v28, v161 row_newbcast:8 row_mask:0xf bank_mask:0xf
    v_and_b32_dpp v34, v28, v162 row_newbcast:8 row_mask:0xf bank_mask:0xf
    v_and_b32_dpp v35, v28, v163 row_newbcast:8 row_mask:0xf bank_mask:0xf
    s_waitcnt vmcnt(3)
    s_addk_i32 s47, 0x2000
    s_bitset0_b32 s47, 17
    buffer_load_dwordx4 v[144:147], v1, s[28:31], s47 offen offset:0 nt
    s_nop 0
    v_mfma_f32_16x16x32_bf16 v[164:167], v[32:35], v[128:131], v[164:167]
    v_and_b32_dpp v36, v28, v160 row_newbcast:9 row_mask:0xf bank_mask:0xf
    v_and_b32_dpp v37, v28, v161 row_newbcast:9 row_mask:0xf bank_mask:0xf
    v_and_b32_dpp v38, v28, v162 row_newbcast:9 row_mask:0xf bank_mask:0xf
    v_and_b32_dpp v39, v28, v163 row_newbcast:9 row_mask:0xf bank_mask:0xf
    s_waitcnt vmcnt(3)
    s_addk_i32 s47, 0x2000
    s_bitset0_b32 s47, 17
    buffer_load_dwordx4 v[148:151], v1, s[28:31], s47 offen offset:0 nt
    s_nop 0
    v_mfma_f32_16x16x32_bf16 v[164:167], v[36:39], v[132:135], v[164:167]
    v_and_b32_dpp v32, v28, v160 row_newbcast:10 row_mask:0xf bank_mask:0xf
    v_and_b32_dpp v33, v28, v161 row_newbcast:10 row_mask:0xf bank_mask:0xf
    v_and_b32_dpp v34, v28, v162 row_newbcast:10 row_mask:0xf bank_mask:0xf
    v_and_b32_dpp v35, v28, v163 row_newbcast:10 row_mask:0xf bank_mask:0xf
    s_waitcnt vmcnt(3)
    s_addk_i32 s47, 0x2000
    s_bitset0_b32 s47, 17
    buffer_load_dwordx4 v[152:155], v1, s[28:31], s47 offen offset:0 nt
    s_nop 0
    v_mfma_f32_16x16x32_bf16 v[164:167], v[32:35], v[136:139], v[164:167]
    v_and_b32_dpp v36, v28, v160 row_newbcast:11 row_mask:0xf bank_mask:0xf
    v_and_b32_dpp v37, v28, v161 row_newbcast:11 row_mask:0xf bank_mask:0xf
    v_and_b32_dpp v38, v28, v162 row_newbcast:11 row_mask:0xf bank_mask:0xf
    v_and_b32_dpp v39, v28, v163 row_newbcast:11 row_mask:0xf bank_mask:0xf
    s_waitcnt vmcnt(3)
    s_addk_i32 s47, 0x2000
    s_bitset0_b32 s47, 17
    buffer_load_dwordx4 v[156:159], v1, s[28:31], s47 offen offset:0 nt
    v_mov_b32 v29, 6
    ds_write_b32 v31, v29 offset:320
    s_nop 0
    v_mfma_f32_16x16x32_bf16 v[164:167], v[36:39], v[140:143], v[164:167]
    v_and_b32_dpp v32, v28, v160 row_newbcast:12 row_mask:0xf bank_mask:0xf
    v_and_b32_dpp v33, v28, v161 row_newbcast:12 row_mask:0xf bank_mask:0xf
    v_and_b32_dpp v34, v28, v162 row_newbcast:12 row_mask:0xf bank_mask:0xf
    v_and_b32_dpp v35, v28, v163 row_newbcast:12 row_mask:0xf bank_mask:0xf
    s_waitcnt vmcnt(3)
    s_nop 0
    v_mfma_f32_16x16x32_bf16 v[164:167], v[32:35], v[144:147], v[164:167]
    v_and_b32_dpp v36, v28, v160 row_newbcast:13 row_mask:0xf bank_mask:0xf
    v_and_b32_dpp v37, v28, v161 row_newbcast:13 row_mask:0xf bank_mask:0xf
    v_and_b32_dpp v38, v28, v162 row_newbcast:13 row_mask:0xf bank_mask:0xf
    v_and_b32_dpp v39, v28, v163 row_newbcast:13 row_mask:0xf bank_mask:0xf
    v_lshlrev_b32 v8, 2, v30
    ds_read_b32 v10, v3 offset:260
    s_mov_b32 s52, 262144
L_mp3:
    ds_read_b32 v9, v8 offset:288
    s_waitcnt lgkmcnt(0)
    v_cmp_eq_u32 vcc, -1, v9
    s_cbranch_vccz L_mok4
    s_sub_u32 s52, s52, 1
    s_cbranch_scc0 L_mp3
    s_branch L_fail
L_mok4:
    v_readfirstlane_b32 s55, v10
    v_max_f32_dpp v9, v9, v9 row_ror:4 row_mask:0xf bank_mask:0xf
    s_nop 1
    v_max_f32_dpp v9, v9, v9 row_ror:2 row_mask:0xf bank_mask:0xf
    s_nop 1
    v_max_f32_dpp v9, v9, v9 row_ror:1 row_mask:0xf bank_mask:0xf
    s_nop 1
    v_sub_f32 v24, v24, v9
    v_mul_f32 v24, 0x3fb8aa3b, v24
    v_exp_f32 v24, v24
    v_mul_f32 v12, 0x3e000000, v9
    v_mov_b32 v13, 0
    v_mov_b32 v15, 0
    v_mul_f32 v14, v24, v26
    v_and_b32 v11, 1, v2
    v_lshlrev_b32 v11, 4, v11
    v_bfe_u32 v17, v2, 4, 1
    v_lshl_add_u32 v11, v17, 3, v11
    v_and_b32 v17, 6, v2
    v_add_u32 v11, v11, v17
    v_bfe_u32 v17, v2, 3, 1
    v_add_u32 v11, v11, v17
    v_lshlrev_b32 v18, 7, v2
    v_cmp_gt_u32 s[50:51], 32, v2
    v_lshlrev_b32 v17, 4, v2
    v_mov_b32 v25, s46
    v_cndmask_b32 v11, 32, v11, s[50:51]
    v_mov_b32 v27, s46
    s_mul_i32 s54, s3, 528
    v_lshl_add_u32 v11, v11, 4, s54
    v_mov_b32 v19, 1
    s_mul_i32 s48, s44, 4352
    s_lshl_b32 s54, s45, 4
    s_add_u32 s48, s48, s54
    s_add_u32 s48, s48, 327680
    s_waitcnt vmcnt(2)
    s_nop 0
    v_mfma_f32_16x16x32_bf16 v[164:167], v[36:39], v[148:151], v[164:167]
    v_and_b32_dpp v32, v28, v160 row_newbcast:14 row_mask:0xf bank_mask:0xf
    v_and_b32_dpp v33, v28, v161 row_newbcast:14 row_mask:0xf bank_mask:0xf
    v_and_b32_dpp v34, v28, v162 row_newbcast:14 row_mask:0xf bank_mask:0xf
    v_and_b32_dpp v35, v28, v163 row_newbcast:14 row_mask:0xf bank_mask:0xf
    s_waitcnt vmcnt(1)
    s_nop 0
    v_mfma_f32_16x16x32_bf16 v[164:167], v[32:35], v[152:155], v[164:167]
    v_and_b32_dpp v36, v28, v160 row_newbcast:15 row_mask:0xf bank_mask:0xf
    v_and_b32_dpp v37, v28, v161 row_newbcast:15 row_mask:0xf bank_mask:0xf
    v_and_b32_dpp v38, v28, v162 row_newbcast:15 row_mask:0xf bank_mask:0xf
    v_and_b32_dpp v39, v28, v163 row_newbcast:15 row_mask:0xf bank_mask:0xf
    s_waitcnt vmcnt(0)
    s_nop 0
    v_mfma_f32_16x16x32_bf16 v[164:167], v[36:39], v[156:159], v[164:167]
    s_mov_b32 exec_hi, 0
    s_nop 6
    v_mul_f32 v12, v24, v164
    v_mul_f32 v13, v24, v165
    v_mul_f32 v14, v24, v166
    v_mul_f32 v15, v24, v167
    s_mov_b32 exec_hi, 1
    ds_write_b128 v11, v[12:15] offset:1024
    s_waitcnt lgkmcnt(0)
    s_barrier
    s_cmp_lg_u32 s3, 7
    s_cbranch_scc1 L_main_done
    ds_read_b128 v[32:35], v17 offset:1024
    ds_read_b128 v[36:39], v17 offset:1552
    ds_read_b128 v[40:43], v17 offset:2080
    ds_read_b128 v[44:47], v17 offset:2608
    ds_read_b128 v[48:51], v17 offset:3136
    ds_read_b128 v[52:55], v17 offset:3664
    ds_read_b128 v[56:59], v17 offset:4192
    ds_read_b128 v[60:63], v17 offset:4720
    s_waitcnt lgkmcnt(6)
    v_pk_add_f32 v[32:33], v[32:33], v[36:37]
    v_pk_add_f32 v[34:35], v[34:35], v[38:39]
    s_waitcnt lgkmcnt(4)
    v_pk_add_f32 v[40:41], v[40:41], v[44:45]
    v_pk_add_f32 v[42:43], v[42:43], v[46:47]
    s_waitcnt lgkmcnt(2)
    v_pk_add_f32 v[48:49], v[48:49], v[52:53]
    v_pk_add_f32 v[50:51], v[50:51], v[54:55]
    s_waitcnt lgkmcnt(0)
    v_pk_add_f32 v[56:57], v[56:57], v[60:61]
    v_pk_add_f32 v[58:59], v[58:59], v[62:63]
    v_pk_add_f32 v[32:33], v[32:33], v[40:41]
    v_pk_add_f32 v[34:35], v[34:35], v[42:43]
    v_pk_add_f32 v[48:49], v[48:49], v[56:57]
    v_pk_add_f32 v[50:51], v[50:51], v[58:59]
    v_pk_add_f32 v[32:33], v[32:33], v[48:49]
    v_pk_add_f32 v[34:35], v[34:35], v[50:51]
    v_cvt_pk_bf16_f32 v24, v32, v33
    v_cvt_pk_bf16_f32 v26, v34, v35
    v_cndmask_b32 v24, v32, v24, s[50:51]
    v_cndmask_b32 v26, v34, v26, s[50:51]
    s_cmp_lg_u32 s55, 1
    s_cbranch_scc1 L_sl5
    buffer_store_dwordx4 v[24:27], v18, s[36:39], s48 offen
L_dn6:
    s_barrier
L_main_done:
    s_endpgm
L_aux2:
    s_mov_b32 s36, s26
    s_mov_b32 s37, s27
    s_mov_b32 s38, 1048576
    s_mov_b32 s39, 0x20000
    s_and_b32 s50, s2, 7
    s_lshr_b32 s51, s2, 3
    s_mov_b32 s56, 0x120b0700
    s_mov_b32 s57, 0x28211d16
    s_lshl_b32 s53, s50, 3
    s_lshr_b64 s[56:57], s[56:57], s53
    s_and_b32 s56, s56, 0xff
    s_lshl_b32 s53, s50, 2
    s_lshr_b32 s57, 0x37474747, s53
    s_and_b32 s57, s57, 15
    s_cmp_eq_u32 s3, 3
    s_cbranch_scc1 L_aux3
    s_cmp_eq_u32 s3, 2
    s_cbranch_scc1 L_setD
    v_and_b32 v17, 1, v11
    v_lshlrev_b32 v29, 5, v17
    v_lshrrev_b32 v17, 5, v2
    v_lshl_add_u32 v29, v17, 4, v29
    s_cmp_eq_u32 s3, 1
    s_cbranch_scc1 L_setA
    s_lshr_b32 s55, s45, 1
    v_lshl_add_u32 v29, v30, 6, v29
    s_lshl_b32 s54, s44, 3
    s_add_u32 s54, s54, s45
    s_lshl_b32 s54, s54, 9
    s_add_u32 s54, s54, 4096
    s_mov_b32 s56, 0xff00ff00
    s_mov_b32 s57, 0xff00ff00
    s_mov_b64 s[28:29], s[56:57]
    v_add_u32 v8, 8192, v1
    v_add_u32 v9, 9216, v1
    s_branch L_xload
L_setA:
    s_and_b32 s53, s51, 3
    s_lshl_b32 s53, s53, 1
    s_lshr_b32 s54, s51, 4
    s_add_u32 s53, s53, s54
    s_lshr_b32 s54, s56, 1
    s_add_u32 s53, s53, s54
    s_add_u32 s58, s56, s57
    s_add_u32 s59, s58, 1
    s_lshr_b32 s59, s59, 1
    s_add_u32 s54, s56, 43
    s_lshr_b32 s54, s54, 1
    s_sub_u32 s54, s54, s59
    s_cmp_lt_u32 s53, s59
    s_cselect_b32 s54, 0, s54
    s_add_u32 s53, s53, s54
    s_add_u32 s59, s58, 44
    s_lshr_b32 s59, s59, 1
    s_cmp_ge_u32 s53, s59
    s_cbranch_scc1 L_noA
    s_bfe_u32 s55, s51, 0x20002
    s_lshl_b32 s53, s53, 1
    v_lshlrev_b32 v8, 10, v13
    v_lshl_add_u32 v8, v11, 7, v8
    v_lshl_add_u32 v8, v30, 4, v8
    v_add_u32 v8, 24576, v8
    v_add_u32 v9, 512, v8
    v_lshl_add_u32 v29, v13, 8, v29
    v_and_b32 v17, 3, v2
    v_lshl_add_u32 v29, v17, 6, v29
    v_bfe_u32 v17, v2, 2, 1
    v_add_u32 v17, s53, v17
    v_cmp_le_u32 vcc, 43, v17
    v_subrev_u32 v18, 43, v17
    v_add_u32 v19, 0x800, v29
    v_cndmask_b32 v17, v17, v18, vcc
    v_cndmask_b32 v29, v29, v19, vcc
    v_lshl_add_u32 v29, v17, 12, v29
    v_subrev_u32 v17, s56, v17
    v_add_u32 v13, s53, v13
    v_cmp_le_u32 vcc, 43, v13
    v_cmp_gt_u32 s[56:57], s57, v17
    s_lshl_b32 s54, s55, 9
    s_add_u32 s54, s54, 147456
    v_cndmask_b32 v13, 0, 1, vcc
    s_mov_b32 s28, 0xf0f0f0f0
    s_mov_b32 s29, 0xf0f0f0f0
L_xload:
    v_lshl_add_u32 v12, v10, 2, v11
    s_lshl_b32 s50, s55, 6
    v_add_lshl_u32 v12, v12, s50, 2
    s_lshl_b32 s50, s3, 10
    v_add_u32 v12, s50, v12
    v_add_u32 v14, s50, v1
L_sel:
    v_and_b32 v24, 1, v2
    v_cmp_eq_u32 vcc, 1, v24
    v_mov_b32 v24, 0xffff
    v_mov_b32 v25, 0xffff0000
    v_cndmask_b32 v24, v24, v25, vcc
    v_bfe_u32 v25, v2, 1, 2
    v_cmp_eq_u32 vcc, 0, v25
    s_nop 1
    v_cndmask_b32 v160, 0, v24, vcc
    v_cmp_eq_u32 vcc, 1, v25
    s_nop 1
    v_cndmask_b32 v161, 0, v24, vcc
    v_cmp_eq_u32 vcc, 2, v25
    s_nop 1
    v_cndmask_b32 v162, 0, v24, vcc
    v_cmp_eq_u32 vcc, 3, v25
    s_nop 1
    v_cndmask_b32 v163, 0, v24, vcc
    v_mov_b32 v24, 0x01000100
    v_mov_b32 v25, 0x02020202
    v_mov_b32 v26, 0x0c0c0c0c
    v_mul_lo_u32 v25, v25, v13
    v_add_u32 v24, v24, v25
    v_bfi_b32 v160, v160, v24, v26
    v_bfi_b32 v161, v161, v24, v26
    v_bfi_b32 v162, v162, v24, v26
    v_bfi_b32 v163, v163, v24, v26
    s_waitcnt lgkmcnt(0)
    s_mul_i32 s46, s46, 0x9e3779b1
    s_add_u32 s46, s46, 0x7f4a7c15
    s_waitcnt vmcnt(0)
    ds_write_b128 v14, v[4:7] offset:6144
    ds_read_b32 v14, v12 offset:6144
    v_lshlrev_b32 v16, 16, v4
    v_and_b32 v17, 0xffff0000, v4
    v_lshlrev_b32 v18, 16, v5
    v_and_b32 v19, 0xffff0000, v5
    v_lshlrev_b32 v20, 16, v6
    v_and_b32 v21, 0xffff0000, v6
    v_lshlrev_b32 v22, 16, v7
    v_and_b32 v23, 0xffff0000, v7
    v_add_f32 v12, v16, v17
    v_add_f32 v12, v12, v18
    v_add_f32 v12, v12, v19
    v_add_f32 v12, v12, v20
    v_add_f32 v12, v12, v21
    v_add_f32 v12, v12, v22
    v_add_f32 v12, v12, v23
    s_nop 1
    v_add_f32_dpp v12, v12, v12 row_ror:8 row_mask:0xf bank_mask:0xf
    s_nop 1
    v_add_f32_dpp v12, v12, v12 row_ror:4 row_mask:0xf bank_mask:0xf
    s_nop 1
    v_add_f32_dpp v12, v12, v12 row_ror:2 row_mask:0xf bank_mask:0xf
    s_nop 1
    v_add_f32_dpp v12, v12, v12 row_ror:1 row_mask:0xf bank_mask:0xf
    v_mov_b32 v31, v12
    s_nop 1
    v_permlane16_swap_b32 v31, v12
    s_nop 0
    v_add_f32 v12, v12, v31
    v_mov_b32 v31, v12
    s_nop 1
    v_permlane32_swap_b32 v31, v12
    s_nop 0
    v_add_f32 v12, v12, v31
    v_mul_f32 v12, 0x3b000000, v12
    v_sub_f32 v31, v16, v12
    v_mul_f32 v13, v31, v31
    v_sub_f32 v31, v17, v12
    v_fmac_f32 v13, v31, v31
    v_sub_f32 v31, v18, v12
    v_fmac_f32 v13, v31, v31
    v_sub_f32 v31, v19, v12
    v_fmac_f32 v13, v31, v31
    v_sub_f32 v31, v20, v12
    v_fmac_f32 v13, v31, v31
    v_sub_f32 v31, v21, v12
    v_fmac_f32 v13, v31, v31
    v_sub_f32 v31, v22, v12
    v_fmac_f32 v13, v31, v31
    v_sub_f32 v31, v23, v12
    v_fmac_f32 v13, v31, v31
    s_nop 1
    v_add_f32_dpp v13, v13, v13 row_ror:8 row_mask:0xf bank_mask:0xf
    s_nop 1
    v_add_f32_dpp v13, v13, v13 row_ror:4 row_mask:0xf bank_mask:0xf
    s_nop 1
    v_add_f32_dpp v13, v13, v13 row_ror:2 row_mask:0xf bank_mask:0xf
    s_nop 1
    v_add_f32_dpp v13, v13, v13 row_ror:1 row_mask:0xf bank_mask:0xf
    v_mov_b32 v31, v13
    s_nop 1
    v_permlane16_swap_b32 v31, v13
    s_nop 0
    v_add_f32 v13, v13, v31
    v_mov_b32 v31, v13
    s_nop 1
    v_permlane32_swap_b32 v31, v13
    s_nop 0
    v_add_f32 v13, v13, v31
    v_mul_f32 v13, 0x3b000000, v13
    v_cvt_pk_bf16_f32 v12, v12, v12
    v_and_b32 v12, 0xffff0000, v12
    v_cvt_pk_bf16_f32 v13, v13, v13
    v_and_b32 v13, 0xffff0000, v13
    v_add_f32 v13, 0x3727c5ac, v13
    v_cvt_pk_bf16_f32 v13, v13, v13
    v_and_b32 v13, 0xffff0000, v13
    v_sqrt_f32 v13, v13
    s_nop 0
    v_cvt_pk_bf16_f32 v13, v13, v13
    v_and_b32 v13, 0xffff0000, v13
    v_rcp_f32 v13, v13
    s_nop 0
    s_waitcnt lgkmcnt(0)
    v_lshlrev_b32 v16, 16, v14
    v_and_b32 v17, 0xffff0000, v14
    v_sub_f32 v16, v16, v12
    v_cvt_pk_bf16_f32 v16, v16, v16
    v_and_b32 v16, 0xffff0000, v16
    v_mul_f32 v16, v16, v13
    v_sub_f32 v17, v17, v12
    v_cvt_pk_bf16_f32 v17, v17, v17
    v_and_b32 v17, 0xffff0000, v17
    v_mul_f32 v17, v17, v13
    v_cvt_pk_bf16_f32 v28, v16, v17
L_gemv:
    s_mov_b32 s52, 262144
L_sw7:
    ds_read_b32 v24, v15 offset:320
    s_waitcnt lgkmcnt(0)
    v_cmp_ge_u32 vcc, s3, v24
    s_cbranch_vccz L_swok8
    s_sleep 1
    s_sub_u32 s52, s52, 1
    s_cbranch_scc0 L_sw7
    s_branch L_fail
L_swok8:
    ds_read_b128 v[32:35], v8 offset:0
    ds_read_b128 v[36:39], v9 offset:0
    ds_read_b128 v[40:43], v8 offset:2048
    ds_read_b128 v[44:47], v9 offset:2048
    ds_read_b128 v[48:51], v8 offset:4096
    ds_read_b128 v[52:55], v9 offset:4096
    ds_read_b128 v[56:59], v8 offset:6144
    ds_read_b128 v[60:63], v9 offset:6144
    ds_read_b128 v[64:67], v8 offset:8192
    ds_read_b128 v[68:71], v9 offset:8192
    ds_read_b128 v[72:75], v8 offset:10240
    ds_read_b128 v[76:79], v9 offset:10240
    ds_read_b128 v[80:83], v8 offset:12288
    ds_read_b128 v[84:87], v9 offset:12288
    ds_read_b128 v[88:91], v8 offset:14336
    ds_read_b128 v[92:95], v9 offset:14336
    v_mov_b32_dpp v24, v28 row_newbcast:0 row_mask:0xf bank_mask:0xf
    v_perm_b32 v16, v24, v24, v160
    v_perm_b32 v17, v24, v24, v161
    v_perm_b32 v18, v24, v24, v162
    v_perm_b32 v19, v24, v24, v163
    s_waitcnt lgkmcnt(12)
    s_nop 0
    v_mfma_f32_16x16x32_bf16 v[164:167], v[16:19], v[32:35], 0
    v_mov_b32_dpp v24, v28 row_newbcast:1 row_mask:0xf bank_mask:0xf
    v_perm_b32 v20, v24, v24, v160
    v_perm_b32 v21, v24, v24, v161
    v_perm_b32 v22, v24, v24, v162
    v_perm_b32 v23, v24, v24, v163
    s_nop 1
    v_mfma_f32_16x16x32_bf16 v[164:167], v[20:23], v[36:39], v[164:167]
    v_mov_b32_dpp v24, v28 row_newbcast:2 row_mask:0xf bank_mask:0xf
    v_perm_b32 v16, v24, v24, v160
    v_perm_b32 v17, v24, v24, v161
    v_perm_b32 v18, v24, v24, v162
    v_perm_b32 v19, v24, v24, v163
    s_nop 1
    v_mfma_f32_16x16x32_bf16 v[164:167], v[16:19], v[40:43], v[164:167]
    v_mov_b32_dpp v24, v28 row_newbcast:3 row_mask:0xf bank_mask:0xf
    v_perm_b32 v20, v24, v24, v160
    v_perm_b32 v21, v24, v24, v161
    v_perm_b32 v22, v24, v24, v162
    v_perm_b32 v23, v24, v24, v163
    s_nop 1
    v_mfma_f32_16x16x32_bf16 v[164:167], v[20:23], v[44:47], v[164:167]
    v_mov_b32_dpp v24, v28 row_newbcast:4 row_mask:0xf bank_mask:0xf
    v_perm_b32 v16, v24, v24, v160
    v_perm_b32 v17, v24, v24, v161
    v_perm_b32 v18, v24, v24, v162
    v_perm_b32 v19, v24, v24, v163
    s_waitcnt lgkmcnt(8)
    s_nop 0
    v_mfma_f32_16x16x32_bf16 v[164:167], v[16:19], v[48:51], v[164:167]
    v_mov_b32_dpp v24, v28 row_newbcast:5 row_mask:0xf bank_mask:0xf
    v_perm_b32 v20, v24, v24, v160
    v_perm_b32 v21, v24, v24, v161
    v_perm_b32 v22, v24, v24, v162
    v_perm_b32 v23, v24, v24, v163
    s_nop 1
    v_mfma_f32_16x16x32_bf16 v[164:167], v[20:23], v[52:55], v[164:167]
    v_mov_b32_dpp v24, v28 row_newbcast:6 row_mask:0xf bank_mask:0xf
    v_perm_b32 v16, v24, v24, v160
    v_perm_b32 v17, v24, v24, v161
    v_perm_b32 v18, v24, v24, v162
    v_perm_b32 v19, v24, v24, v163
    s_nop 1
    v_mfma_f32_16x16x32_bf16 v[164:167], v[16:19], v[56:59], v[164:167]
    v_mov_b32_dpp v24, v28 row_newbcast:7 row_mask:0xf bank_mask:0xf
    v_perm_b32 v20, v24, v24, v160
    v_perm_b32 v21, v24, v24, v161
    v_perm_b32 v22, v24, v24, v162
    v_perm_b32 v23, v24, v24, v163
    s_nop 1
    v_mfma_f32_16x16x32_bf16 v[164:167], v[20:23], v[60:63], v[164:167]
    v_mov_b32_dpp v24, v28 row_newbcast:8 row_mask:0xf bank_mask:0xf
    v_perm_b32 v16, v24, v24, v160
    v_perm_b32 v17, v24, v24, v161
    v_perm_b32 v18, v24, v24, v162
    v_perm_b32 v19, v24, v24, v163
    s_waitcnt lgkmcnt(4)
    s_nop 0
    v_mfma_f32_16x16x32_bf16 v[164:167], v[16:19], v[64:67], v[164:167]
    v_mov_b32_dpp v24, v28 row_newbcast:9 row_mask:0xf bank_mask:0xf
    v_perm_b32 v20, v24, v24, v160
    v_perm_b32 v21, v24, v24, v161
    v_perm_b32 v22, v24, v24, v162
    v_perm_b32 v23, v24, v24, v163
    s_nop 1
    v_mfma_f32_16x16x32_bf16 v[164:167], v[20:23], v[68:71], v[164:167]
    v_mov_b32_dpp v24, v28 row_newbcast:10 row_mask:0xf bank_mask:0xf
    v_perm_b32 v16, v24, v24, v160
    v_perm_b32 v17, v24, v24, v161
    v_perm_b32 v18, v24, v24, v162
    v_perm_b32 v19, v24, v24, v163
    s_nop 1
    v_mfma_f32_16x16x32_bf16 v[164:167], v[16:19], v[72:75], v[164:167]
    v_mov_b32_dpp v24, v28 row_newbcast:11 row_mask:0xf bank_mask:0xf
    v_perm_b32 v20, v24, v24, v160
    v_perm_b32 v21, v24, v24, v161
    v_perm_b32 v22, v24, v24, v162
    v_perm_b32 v23, v24, v24, v163
    s_nop 1
    v_mfma_f32_16x16x32_bf16 v[164:167], v[20:23], v[76:79], v[164:167]
    v_mov_b32_dpp v24, v28 row_newbcast:12 row_mask:0xf bank_mask:0xf
    v_perm_b32 v16, v24, v24, v160
    v_perm_b32 v17, v24, v24, v161
    v_perm_b32 v18, v24, v24, v162
    v_perm_b32 v19, v24, v24, v163
    s_waitcnt lgkmcnt(0)
    s_nop 0
    v_mfma_f32_16x16x32_bf16 v[164:167], v[16:19], v[80:83], v[164:167]
    v_mov_b32_dpp v24, v28 row_newbcast:13 row_mask:0xf bank_mask:0xf
    v_perm_b32 v20, v24, v24, v160
    v_perm_b32 v21, v24, v24, v161
    v_perm_b32 v22, v24, v24, v162
    v_perm_b32 v23, v24, v24, v163
    s_nop 1
    v_mfma_f32_16x16x32_bf16 v[164:167], v[20:23], v[84:87], v[164:167]
    v_mov_b32_dpp v24, v28 row_newbcast:14 row_mask:0xf bank_mask:0xf
    v_perm_b32 v16, v24, v24, v160
    v_perm_b32 v17, v24, v24, v161
    v_perm_b32 v18, v24, v24, v162
    v_perm_b32 v19, v24, v24, v163
    s_nop 1
    v_mfma_f32_16x16x32_bf16 v[164:167], v[16:19], v[88:91], v[164:167]
    v_mov_b32_dpp v24, v28 row_newbcast:15 row_mask:0xf bank_mask:0xf
    v_perm_b32 v20, v24, v24, v160
    v_perm_b32 v21, v24, v24, v161
    v_perm_b32 v22, v24, v24, v162
    v_perm_b32 v23, v24, v24, v163
    s_nop 1
    v_mfma_f32_16x16x32_bf16 v[164:167], v[20:23], v[92:95], v[164:167]
    v_mov_b32 v25, s46
    v_mov_b32 v27, s46
    s_nop 5
    v_permlane32_swap_b32 v164, v166
    v_permlane32_swap_b32 v165, v167
    s_nop 0
    v_cndmask_b32 v24, v164, v166, s[28:29]
    v_cndmask_b32 v26, v165, v167, s[28:29]
    s_cmp_lg_u32 s3, 0
    s_cbranch_scc1 L_pub
    v_add_f32_dpp v24, v24, v24 row_ror:8 row_mask:0xf bank_mask:0xf
    v_add_f32_dpp v26, v26, v26 row_ror:8 row_mask:0xf bank_mask:0xf
L_pub:
    s_mov_b64 exec, s[56:57]
    buffer_store_dwordx4 v[24:27], v29, s[36:39], s54 offen
    s_mov_b64 exec, -1
    s_cmp_lg_u32 s3, 0
    s_cbranch_scc1 L_repub
    s_lshl_b32 s48, s44, 12
    s_add_u32 s48, s48, 4096
    v_mov_b32 v22, v24
    s_mov_b32 s52, 262144
L_sw9:
    ds_read_b32 v24, v15 offset:320
    s_waitcnt lgkmcnt(0)
    v_cmp_gt_u32 vcc, 3, v24
    s_cbranch_vccz L_swok10
    s_sleep 4
    s_sub_u32 s52, s52, 1
    s_cbranch_scc0 L_sw9
    s_branch L_fail
L_swok10:
    v_mov_b32 v24, v22
    s_mov_b32 s52, 262144
L_qp:
    buffer_load_dwordx4 v[32:35], v1, s[36:39], s48 offen offset:0 nt
    buffer_load_dwordx4 v[36:39], v1, s[36:39], s48 offen offset:1024 nt
    buffer_load_dwordx4 v[40:43], v1, s[36:39], s48 offen offset:2048 nt
    buffer_load_dwordx4 v[44:47], v1, s[36:39], s48 offen offset:3072 nt
L_qc:
    ds_read_b32 v21, v3 offset:260
    s_waitcnt vmcnt(0) lgkmcnt(0)
    v_xor_b32 v20, s46, v33
    v_bitop3_b32 v20, v20, v35, s46 bitop3:0xf6
    v_bitop3_b32 v20, v20, v37, s46 bitop3:0xf6
    v_bitop3_b32 v20, v20, v39, s46 bitop3:0xf6
    v_bitop3_b32 v20, v20, v41, s46 bitop3:0xf6
    v_bitop3_b32 v20, v20, v43, s46 bitop3:0xf6
    v_bitop3_b32 v20, v20, v45, s46 bitop3:0xf6
    v_bitop3_b32 v20, v20, v47, s46 bitop3:0xf6
    v_readfirstlane_b32 s55, v21
    v_cmp_ne_u32 vcc, 0, v20
    s_cbranch_vccz L_qok
    s_sub_u32 s52, s52, 1
    s_cbranch_scc1 L_fail
    s_cmp_lg_u32 s55, 2
    s_cbranch_scc1 L_qp
    s_branch L_qslow
L_qok:
    v_add_f32 v32, v32, v36
    v_add_f32 v34, v34, v38
    v_add_f32 v32, v32, v40
    v_add_f32 v34, v34, v42
    v_add_f32 v32, v32, v44
    v_add_f32 v34, v34, v46
    v_lshlrev_b32 v12, 2, v2
    v_mov_b32 v14, 1
    v_cvt_pk_bf16_f32 v13, v32, v34
    ds_write_b32 v12, v13 offset:0
    ds_write_b32 v3, v14 offset:256
L_repub:
    s_mov_b32 s52, 262144
L_md11:
    ds_read_b32 v20, v3 offset:260
    s_waitcnt lgkmcnt(0)
    v_readfirstlane_b32 s55, v20
    s_cmp_lg_u32 s55, 0
    s_cbranch_scc1 L_mdok12
    s_sleep 2
    s_sub_u32 s52, s52, 1
    s_cbranch_scc0 L_md11
    s_branch L_fail
L_mdok12:
    s_cmp_eq_u32 s55, 1
    s_cbranch_scc1 L_tail
    s_mov_b64 exec, s[56:57]
    buffer_store_dwordx4 v[24:27], v29, s[36:39], s54 offen sc1
    s_mov_b64 exec, -1
    s_branch L_tail
L_setD:
    s_and_b32 s53, s51, 3
    s_cmp_lg_u32 s53, 3
    s_cbranch_scc1 L_idle
    s_sub_u32 s53, 7, s45
    s_cmp_ge_u32 s53, s57
    s_cbranch_scc1 L_idle
    s_add_u32 s53, s53, s56
    s_lshl_b32 s48, s53, 12
    s_add_u32 s48, s48, 147456
    s_mov_b32 s52, 262144
L_md13:
    ds_read_b32 v20, v3 offset:260
    s_waitcnt lgkmcnt(0)
    v_readfirstlane_b32 s55, v20
    s_cmp_lg_u32 s55, 0
    s_cbranch_scc1 L_mdok14
    s_sleep 2
    s_sub_u32 s52, s52, 1
    s_cbranch_scc0 L_md13
    s_branch L_fail
L_mdok14:
    s_mul_i32 s46, s46, 0x9e3779b1
    s_add_u32 s46, s46, 0x7f4a7c15
    s_mov_b32 s52, 262144
L_sw15:
    ds_read_b32 v24, v15 offset:320
    s_waitcnt lgkmcnt(0)
    v_cmp_gt_u32 vcc, 3, v24
    s_cbranch_vccz L_swok16
    s_sleep 4
    s_sub_u32 s52, s52, 1
    s_cbranch_scc0 L_sw15
    s_branch L_fail
L_swok16:
    s_mov_b32 s52, 262144
L_lp17:
    s_cmp_lg_u32 s55, 1
    s_cbranch_scc1 L_ls18
    buffer_load_dwordx4 v[96:99], v1, s[36:39], s48 offen offset:0 nt
    buffer_load_dwordx4 v[100:103], v1, s[36:39], s48 offen offset:1024 nt
    buffer_load_dwordx4 v[104:107], v1, s[36:39], s48 offen offset:2048 nt
    buffer_load_dwordx4 v[108:111], v1, s[36:39], s48 offen offset:3072 nt
L_lc19:
    s_waitcnt vmcnt(0)
    v_xor_b32 v24, s46, v97
    v_bitop3_b32 v24, v24, v99, s46 bitop3:0xf6
    v_bitop3_b32 v24, v24, v101, s46 bitop3:0xf6
    v_bitop3_b32 v24, v24, v103, s46 bitop3:0xf6
    v_bitop3_b32 v24, v24, v105, s46 bitop3:0xf6
    v_bitop3_b32 v24, v24, v107, s46 bitop3:0xf6
    v_bitop3_b32 v24, v24, v109, s46 bitop3:0xf6
    v_bitop3_b32 v24, v24, v111, s46 bitop3:0xf6
    v_cmp_ne_u32 vcc, 0, v24
    s_cbranch_vccz L_lo20
    s_sleep 8
    s_sub_u32 s52, s52, 1
    s_cbranch_scc0 L_lp17
    s_branch L_fail
L_lo20:
    v_add_f32 v96, v96, v100
    v_add_f32 v98, v98, v102
    v_add_f32 v96, v96, v104
    v_add_f32 v98, v98, v106
    v_add_f32 v96, v96, v108
    v_add_f32 v98, v98, v110
    v_mov_b32 v16, v96
    v_mov_b32 v17, v98
    s_nop 0
    v_permlane32_swap_b32 v16, v96
    v_permlane32_swap_b32 v17, v98
    v_add_f32 v100, v16, v96
    v_add_f32 v102, v17, v98
    v_mov_b32 v96, v100
    v_mov_b32 v98, v102
    s_nop 0
    v_permlane16_swap_b32 v96, v100
    v_permlane16_swap_b32 v98, v102
    v_cvt_pk_bf16_f32 v96, v96, v96
    v_and_b32 v96, 0xffff0000, v96
    v_cvt_pk_bf16_f32 v100, v100, v100
    v_and_b32 v100, 0xffff0000, v100
    v_mul_f32 v20, v96, v96
    v_mul_f32 v20, 0x3d372713, v20
    v_fma_f32 v20, v20, v96, v96
    v_mul_f32 v20, 0xc0135761, v20
    v_exp_f32 v20, v20
    s_nop 0
    v_add_f32 v20, 1.0, v20
    v_rcp_f32 v20, v20
    s_nop 0
    v_mul_f32 v96, v96, v20
    v_cvt_pk_bf16_f32 v96, v96, v96
    v_and_b32 v96, 0xffff0000, v96
    v_mul_f32 v96, v96, v100
    v_cvt_pk_bf16_f32 v98, v98, v98
    v_and_b32 v98, 0xffff0000, v98
    v_cvt_pk_bf16_f32 v102, v102, v102
    v_and_b32 v102, 0xffff0000, v102
    v_mul_f32 v20, v98, v98
    v_mul_f32 v20, 0x3d372713, v20
    v_fma_f32 v20, v20, v98, v98
    v_mul_f32 v20, 0xc0135761, v20
    v_exp_f32 v20, v20
    s_nop 0
    v_add_f32 v20, 1.0, v20
    v_rcp_f32 v20, v20
    s_nop 0
    v_mul_f32 v98, v98, v20
    v_cvt_pk_bf16_f32 v98, v98, v98
    v_and_b32 v98, 0xffff0000, v98
    v_mul_f32 v98, v98, v102
    v_cvt_pk_bf16_f32 v24, v96, v98
    v_mov_b32 v25, s46
    v_lshlrev_b32 v29, 3, v2
    s_lshl_b32 s54, s53, 7
    s_add_u32 s54, s54, 491520
    s_mov_b64 exec, 0xffff
    s_cmp_lg_u32 s55, 1
    s_cbranch_scc1 L_sl21
    buffer_store_dwordx2 v[24:25], v29, s[36:39], s54 offen
L_dn22:
    s_mov_b64 exec, -1
    s_branch L_tail
L_aux3:
    s_getreg_b32 s53, hwreg(HW_REG_XCC_ID, 0, 4)
    s_lshl_b32 s48, s50, 7
    s_add_u32 s48, s48, 2048
    s_lshl_b32 s49, s51, 2
    s_add_u32 s49, s49, s48
    v_lshlrev_b32 v13, 2, v2
    s_waitcnt lgkmcnt(0)
    s_mul_i32 s46, s46, 0x9e3779b1
    s_add_u32 s46, s46, 0x7f4a7c15
    s_add_u32 s53, s53, s46
    v_mov_b32 v24, s53
    s_mov_b64 exec, 1
    buffer_store_dword v24, v3, s[36:39], s49 offen
    s_mov_b32 exec_lo, -1
    s_mov_b32 s52, 16
    s_mov_b32 s55, 1
L_hello:
    s_sleep 8
    buffer_load_dword v26, v13, s[36:39], s48 offen nt
    s_waitcnt vmcnt(0)
    v_cmp_ne_u32 vcc, s53, v26
    s_cbranch_vccz L_hello_ok
    s_sub_u32 s52, s52, 1
    s_cbranch_scc0 L_hello
    s_mov_b32 s55, 2
L_hello_ok:
    s_mov_b64 exec, -1
    v_mov_b32 v26, s55
    ds_write_b32 v3, v26 offset:260
    s_lshl_b32 s58, s57, 2
    s_and_b32 s48, s51, 3
    s_mul_i32 s48, s48, s58
    s_lshl_b32 s49, s56, 4
    s_add_u32 s48, s48, s49
    s_lshl_b32 s48, s48, 3
    s_add_u32 s48, s48, 491520
    v_cmp_gt_u32 s[28:29], s58, v2
    v_lshlrev_b32 v16, 3, v2
    s_nop 0
    v_cndmask_b32 v16, 0, v16, s[28:29]
    s_mov_b32 s52, 262144
L_sw23:
    ds_read_b32 v24, v15 offset:320
    s_waitcnt lgkmcnt(0)
    v_cmp_gt_u32 vcc, 4, v24
    s_cbranch_vccz L_swok24
    s_sleep 8
    s_sub_u32 s52, s52, 1
    s_cbranch_scc0 L_sw23
    s_branch L_fail
L_swok24:
    s_mov_b32 s52, 262144
L_lp25:
    s_cmp_lg_u32 s55, 1
    s_cbranch_scc1 L_ls26
    buffer_load_dwordx2 v[32:33], v16, s[36:39], s48 offen nt
L_lc27:
    s_waitcnt vmcnt(0)
    v_xor_b32 v24, s46, v33
    v_cmp_ne_u32 vcc, 0, v24
    s_cbranch_vccz L_lo28
    s_sleep 2
    s_sub_u32 s52, s52, 1
    s_cbranch_scc0 L_lp25
    s_branch L_fail
L_lo28:
    v_cndmask_b32 v32, 0, v32, s[28:29]
    s_mov_b32 exec_hi, 0
    ds_write_b32 v13, v32 offset:384
    s_mov_b32 exec_hi, -1
    s_branch L_tail
L_noA:
    s_and_b32 s53, s44, 25
    s_cmp_lg_u32 s53, 25
    s_cbranch_scc1 L_idle
    s_waitcnt lgkmcnt(0)
    s_mul_i32 s46, s46, 0x9e3779b1
    s_add_u32 s46, s46, 0x7f4a7c15
    s_cmp_lg_u32 s2, 25
    s_cbranch_scc1 L_recv
    s_mov_b32 s58, -1
    s_mov_b32 s59, -1
    s_mov_b32 s52, 4
L_probe:
    s_memtime s[28:29]
    s_waitcnt lgkmcnt(0)
    s_load_dword s53, s[26:27], 0x7c000 glc
    s_waitcnt lgkmcnt(0)
    s_memtime s[30:31]
    s_waitcnt lgkmcnt(0)
    s_sub_u32 s28, s30, s28
    s_min_u32 s58, s58, s28
    s_memtime s[28:29]
    s_waitcnt lgkmcnt(0)
    s_load_dword s53, s[26:27], 0x7e000 glc
    s_waitcnt lgkmcnt(0)
    s_memtime s[30:31]
    s_waitcnt lgkmcnt(0)
    s_sub_u32 s28, s30, s28
    s_min_u32 s59, s59, s28
    s_sub_u32 s52, s52, 1
    s_cmp_lg_u32 s52, 0
    s_cbranch_scc1 L_probe
    s_cmp_gt_u32 s58, s59
    s_cselect_b32 s53, 2, 0
    v_mov_b32 v24, s53
    v_mov_b32 v25, s46
    v_lshlrev_b32 v16, 7, v2
    s_mov_b32 s48, 499712
    s_mov_b32 exec_hi, 0
    buffer_store_dwordx2 v[24:25], v16, s[36:39], s48 offen sc1
    s_mov_b32 exec_hi, -1
L_recv:
    s_bfe_u32 s48, s44, 0x20001
    s_lshl_b32 s48, s48, 3
    s_add_u32 s48, s48, s45
    s_lshl_b32 s48, s48, 7
    s_add_u32 s48, s48, 499712
    s_mov_b32 s52, 262144
L_sw29:
    ds_read_b32 v24, v15 offset:320
    s_waitcnt lgkmcnt(0)
    v_cmp_gt_u32 vcc, 4, v24
    s_cbranch_vccz L_swok30
    s_sleep 8
    s_sub_u32 s52, s52, 1
    s_cbranch_scc0 L_sw29
    s_branch L_fail
L_swok30:
    s_mov_b32 s52, 262144
L_poll31:
    buffer_load_dwordx2 v[32:33], v3, s[36:39], s48 offen sc1
    s_waitcnt vmcnt(0)
    v_xor_b32 v24, s46, v33
    v_cmp_ne_u32 vcc, 0, v24
    s_cbranch_vccz L_ok32
    s_sleep 8
    s_sub_u32 s52, s52, 1
    s_cbranch_scc0 L_poll31
    s_branch L_fail
L_ok32:
    v_add_u32 v32, 1, v32
    ds_write_b32 v3, v32 offset:264
    s_mov_b32 s52, 262144
L_md33:
    ds_read_b32 v24, v3 offset:260
    s_waitcnt lgkmcnt(0)
    v_readfirstlane_b32 s55, v24
    s_cmp_lg_u32 s55, 0
    s_cbranch_scc1 L_mdok34
    s_sleep 2
    s_sub_u32 s52, s52, 1
    s_cbranch_scc0 L_md33
    s_branch L_fail
L_mdok34:
    s_branch L_tail
L_idle:
    s_mov_b32 s52, 262144
L_md35:
    ds_read_b32 v24, v3 offset:260
    s_waitcnt lgkmcnt(0)
    v_readfirstlane_b32 s55, v24
    s_cmp_lg_u32 s55, 0
    s_cbranch_scc1 L_mdok36
    s_sleep 2
    s_sub_u32 s52, s52, 1
    s_cbranch_scc0 L_md35
    s_branch L_fail
L_mdok36:
    s_mul_i32 s46, s46, 0x9e3779b1
    s_add_u32 s46, s46, 0x7f4a7c15
L_tail:
    s_and_b32 s50, s2, 7
    s_lshr_b32 s51, s2, 3
    s_mov_b32 s56, 0x120b0700
    s_mov_b32 s57, 0x28211d16
    s_lshl_b32 s53, s50, 3
    s_lshr_b64 s[56:57], s[56:57], s53
    s_and_b32 s56, s56, 0xff
    s_lshl_b32 s53, s50, 2
    s_lshr_b32 s57, 0x37474747, s53
    s_and_b32 s57, s57, 15
    s_lshl_b32 s53, s45, 2
    s_add_u32 s53, s53, s3
    v_lshlrev_b32 v13, 4, v30
    s_mul_i32 s48, s44, 4352
    s_add_u32 s48, s48, 327680
    s_add_u32 s47, s48, 0x1000
    v_bfe_u32 v12, v2, 2, 2
    v_lshlrev_b32 v12, 7, v12
    v_and_b32 v14, 3, v2
    v_lshl_add_u32 v12, v14, 3, v12
    v_bfe_u32 v14, v2, 3, 2
    v_xor_b32 v14, s3, v14
    v_lshl_add_u32 v12, v14, 5, v12
    v_lshl_add_u32 v14, v11, 10, v12
    v_lshl_add_u32 v12, v11, 11, v12
    v_lshlrev_b32 v29, 4, v11
    s_lshl_b32 s54, s53, 6
    s_add_u32 s54, s54, s44
    s_lshl_b32 s54, s54, 8
    s_add_u32 s54, s54, 524288
    s_lshr_b32 s49, s3, 1
    s_lshl_b32 s49, s49, 13
    s_add_u32 s54, s54, s49
    s_lshl_b32 s49, s53, 5
    v_lshl_add_u32 v8, v10, 1, s49
    s_lshl_b32 s58, s57, 3
    s_and_b32 s28, s51, 3
    s_mul_i32 s28, s28, s58
    s_lshl_b32 s29, s56, 5
    s_add_u32 s28, s28, s29
    s_lshl_b32 s28, s28, 10
    s_lshl_b32 s29, s45, 7
    s_add_u32 s28, s28, s29
    s_add_u32 s40, s20, s28
    s_addc_u32 s41, s21, 0
    s_lshl_b32 s42, s58, 10
    s_sub_u32 s42, s42, 896
    s_mov_b32 s43, 0x20000
    s_lshl_b32 s28, s44, 17
    s_add_u32 s28, s28, s29
    s_add_u32 s56, s12, s28
    s_addc_u32 s57, s13, 0
    s_mov_b32 s58, 130176
    s_mov_b32 s59, 0x20000
    v_lshrrev_b32 v10, 3, v2
    v_lshl_add_u32 v10, v10, 10, v13
    v_and_b32 v28, 16, v2
    v_lshlrev_b32 v28, 1, v28
    v_xor_b32 v10, v10, v28
    v_xor_b32 v28, 64, v10
    s_mov_b32 s50, 0
    s_mov_b32 s51, -1
    s_waitcnt vmcnt(0) lgkmcnt(0)
    v_mov_b32 v25, s46
    v_mov_b32 v27, s46
    s_mov_b32 s34, 0
    s_mov_b32 s35, 0
    s_mov_b32 s33, 9
    s_and_b32 s28, s44, 25
    s_cmp_lg_u32 s28, 25
    s_cbranch_scc1 L_nog
    s_mov_b32 s52, 262144
L_iv:
    ds_read_b32 v24, v3 offset:264
    s_waitcnt lgkmcnt(0)
    v_readfirstlane_b32 s28, v24
    s_cmp_lg_u32 s28, 0
    s_cbranch_scc1 L_ivok
    s_sleep 8
    s_sub_u32 s52, s52, 1
    s_cbranch_scc0 L_iv
    s_branch L_fail
L_ivok:
    s_and_b32 s28, s28, 2
    s_bfe_u32 s33, s44, 0x20001
    s_xor_b32 s33, s33, s28
    s_cmp_lg_u32 s33, s3
    s_cbranch_scc1 L_nog
    global_load_ushort v9, v8, s[4:5]
    s_and_b32 s34, s54, 0xffffe000
    s_add_u32 s35, s34, 0x1000
    s_not_b32 s29, s46
    v_mov_b32 v20, s29
    v_add_u32 v21, 0, v11
    v_cmp_ne_u32 s[6:7], s44, v21
    v_mov_b32 v96, 0
    v_mov_b32 v98, 0
    v_cndmask_b32 v97, v25, v20, s[6:7]
    v_cndmask_b32 v99, v25, v20, s[6:7]
    v_add_u32 v21, 4, v11
    v_cmp_ne_u32 s[8:9], s44, v21
    v_mov_b32 v100, 0
    v_mov_b32 v102, 0
    v_cndmask_b32 v101, v25, v20, s[8:9]
    v_cndmask_b32 v103, v25, v20, s[8:9]
    v_add_u32 v21, 8, v11
    v_cmp_ne_u32 s[10:11], s44, v21
    v_mov_b32 v104, 0
    v_mov_b32 v106, 0
    v_cndmask_b32 v105, v25, v20, s[10:11]
    v_cndmask_b32 v107, v25, v20, s[10:11]
    v_add_u32 v21, 12, v11
    v_cmp_ne_u32 s[14:15], s44, v21
    v_mov_b32 v108, 0
    v_mov_b32 v110, 0
    v_cndmask_b32 v109, v25, v20, s[14:15]
    v_cndmask_b32 v111, v25, v20, s[14:15]
    v_add_u32 v21, 16, v11
    v_cmp_ne_u32 s[16:17], s44, v21
    v_mov_b32 v112, 0
    v_mov_b32 v114, 0
    v_cndmask_b32 v113, v25, v20, s[16:17]
    v_cndmask_b32 v115, v25, v20, s[16:17]
    v_add_u32 v21, 20, v11
    v_cmp_ne_u32 s[18:19], s44, v21
    v_mov_b32 v116, 0
    v_mov_b32 v118, 0
    v_cndmask_b32 v117, v25, v20, s[18:19]
    v_cndmask_b32 v119, v25, v20, s[18:19]
    v_add_u32 v21, 24, v11
    v_cmp_ne_u32 s[24:25], s44, v21
    v_mov_b32 v120, 0
    v_mov_b32 v122, 0
    v_cndmask_b32 v121, v25, v20, s[24:25]
    v_cndmask_b32 v123, v25, v20, s[24:25]
    v_add_u32 v21, 28, v11
    v_cmp_ne_u32 s[30:31], s44, v21
    v_mov_b32 v124, 0
    v_mov_b32 v126, 0
    v_cndmask_b32 v125, v25, v20, s[30:31]
    v_cndmask_b32 v127, v25, v20, s[30:31]
L_nog:
    s_mul_i32 s29, s3, 2
    s_add_u32 s29, s29, 4
    s_min_u32 s29, s29, 8
    s_lshl_b32 s29, s29, 3
    s_mov_b32 s52, 262144
L_lw:
    ds_read_b32 v24, v15 offset:320
    s_waitcnt lgkmcnt(0)
    v_cmp_le_u32 vcc, 6, v24
    s_bcnt1_i32_b64 s28, vcc
    s_cmp_ge_u32 s28, s29
    s_cbranch_scc1 L_lwok
    s_sleep 1
    s_sub_u32 s52, s52, 1
    s_cbranch_scc0 L_lw
    s_branch L_fail
L_lwok:
    s_lshl_b32 s28, s3, 15
    s_lshl_b32 s29, s3, 12
    s_add_u32 m0, s29, 49152
    s_lshl_b32 s32, s3, 14
    buffer_load_dwordx4 v10, s[56:59], s28 offen nt lds
    s_add_u32 m0, s29, 50176
    s_addk_i32 s28, 0x2000
    buffer_load_dwordx4 v10, s[56:59], s28 offen nt lds
    s_add_u32 m0, s29, 51200
    s_addk_i32 s28, 0x2000
    buffer_load_dwordx4 v28, s[56:59], s28 offen nt lds
    s_add_u32 m0, s29, 52224
    s_addk_i32 s28, 0x2000
    buffer_load_dwordx4 v28, s[56:59], s28 offen nt lds
    s_lshl_b32 s29, s3, 11
    s_add_u32 m0, s29, 40960
    s_nop 0
    buffer_load_dwordx4 v10, s[40:43], s32 offen nt lds
    s_add_u32 m0, s29, 41984
    s_addk_i32 s32, 0x2000
    buffer_load_dwordx4 v28, s[40:43], s32 offen nt lds
    s_barrier
    s_barrier
    buffer_load_dwordx4 v[32:35], v1, s[36:39], s48 offen offset:0 nt
    buffer_load_dwordx4 v[36:39], v1, s[36:39], s48 offen offset:1024 nt
    buffer_load_dwordx4 v[40:43], v1, s[36:39], s48 offen offset:2048 nt
    buffer_load_dwordx4 v[44:47], v1, s[36:39], s48 offen offset:3072 nt
    buffer_load_dwordx4 v[48:51], v13, s[36:39], s47 offen nt
    s_waitcnt vmcnt(5)
    s_barrier
    ds_read_b64_tr_b16 v[64:65], v12 offset:49152
    ds_read_b64_tr_b16 v[66:67], v12 offset:49664
    ds_read_b64_tr_b16 v[72:73], v12 offset:57344
    ds_read_b64_tr_b16 v[74:75], v12 offset:57856
    ds_read_b64_tr_b16 v[68:69], v12 offset:50176
    ds_read_b64_tr_b16 v[70:71], v12 offset:50688
    ds_read_b64_tr_b16 v[76:77], v12 offset:58368
    ds_read_b64_tr_b16 v[78:79], v12 offset:58880
    ds_read_b64_tr_b16 v[80:81], v14 offset:40960
    ds_read_b64_tr_b16 v[82:83], v14 offset:41472
    ds_read_b128 v[88:91], v29 offset:384
    ds_read_b64_tr_b16 v[84:85], v14 offset:45056
    ds_read_b64_tr_b16 v[86:87], v14 offset:45568
    ds_read_b128 v[92:95], v29 offset:448
    s_mov_b32 s52, 262144
L_h1c:
    s_waitcnt vmcnt(0)
    v_bitop3_b32 v16, v33, v35, s46 bitop3:0x7e
    v_bitop3_b32 v17, v37, v39, s46 bitop3:0x7e
    v_bitop3_b32 v18, v41, v43, s46 bitop3:0x7e
    v_bitop3_b32 v19, v45, v47, s46 bitop3:0x7e
    v_bitop3_b32 v20, v49, v51, s46 bitop3:0x7e
    v_or3_b32 v16, v16, v17, v18
    v_or3_b32 v16, v16, v19, v20
    v_cmp_ne_u32 vcc, 0, v16
    s_cbranch_vccz L_h1ok
    s_sub_u32 s52, s52, 1
    s_cbranch_scc1 L_fail
    s_cmp_lg_u32 s55, 1
    s_cbranch_scc1 L_h1s
    buffer_load_dwordx4 v[32:35], v1, s[36:39], s48 offen offset:0 nt
    buffer_load_dwordx4 v[36:39], v1, s[36:39], s48 offen offset:1024 nt
    buffer_load_dwordx4 v[40:43], v1, s[36:39], s48 offen offset:2048 nt
    buffer_load_dwordx4 v[44:47], v1, s[36:39], s48 offen offset:3072 nt
    buffer_load_dwordx4 v[48:51], v13, s[36:39], s47 offen nt
    s_branch L_h1c
L_h1ok:
    v_max_f32_dpp v28, v48, v48 row_ror:4 row_mask:0xf bank_mask:0xf
    v_mov_b32 v33, v34
    v_mov_b32 v34, v36
    v_max_f32_dpp v28, v28, v28 row_ror:2 row_mask:0xf bank_mask:0xf
    v_mov_b32 v35, v38
    v_mov_b32 v41, v42
    v_max_f32_dpp v28, v28, v28 row_ror:1 row_mask:0xf bank_mask:0xf
    v_mov_b32 v42, v44
    v_mov_b32 v43, v46
    s_waitcnt lgkmcnt(0)
    v_mfma_f32_16x16x32_bf16 v[16:19], v[32:35], v[64:67], 0
    v_sub_f32 v28, v48, v28
    v_mfma_f32_16x16x32_bf16 v[20:23], v[32:35], v[72:75], 0
    v_mul_f32 v28, 0x3fb8aa3b, v28
    v_mfma_f32_16x16x32_bf16 v[16:19], v[40:43], v[68:71], v[16:19]
    v_exp_f32 v28, v28
    v_mfma_f32_16x16x32_bf16 v[20:23], v[40:43], v[76:79], v[20:23]
    v_mul_f32 v31, v28, v50
    v_mfma_f32_16x16x32_bf16 v[4:7], v[88:91], v[80:83], 0
    s_nop 0
    v_add_f32_dpp v31, v31, v31 row_ror:4 row_mask:0xf bank_mask:0xf
    v_mfma_f32_16x16x32_bf16 v[4:7], v[92:95], v[84:87], v[4:7]
    s_nop 0
    v_add_f32_dpp v31, v31, v31 row_ror:2 row_mask:0xf bank_mask:0xf
    s_nop 1
    v_add_f32_dpp v31, v31, v31 row_ror:1 row_mask:0xf bank_mask:0xf
    v_rcp_f32 v31, v31
    v_cndmask_b32 v16, v16, v20, s[50:51]
    v_cndmask_b32 v17, v17, v21, s[50:51]
    v_cndmask_b32 v18, v18, v22, s[50:51]
    v_cndmask_b32 v19, v19, v23, s[50:51]
    v_mul_f32_dpp v24, v28, v16 row_newbcast:0 row_mask:0x5 bank_mask:0xf
    v_mul_f32_dpp v24, v28, v16 row_newbcast:4 row_mask:0xa bank_mask:0xf
    v_fmac_f32_dpp v24, v28, v17 row_newbcast:1 row_mask:0x5 bank_mask:0xf
    v_fmac_f32_dpp v24, v28, v17 row_newbcast:5 row_mask:0xa bank_mask:0xf
    v_fmac_f32_dpp v24, v28, v18 row_newbcast:2 row_mask:0x5 bank_mask:0xf
    v_fmac_f32_dpp v24, v28, v18 row_newbcast:6 row_mask:0xa bank_mask:0xf
    v_fmac_f32_dpp v24, v28, v19 row_newbcast:3 row_mask:0x5 bank_mask:0xf
    v_fmac_f32_dpp v24, v28, v19 row_newbcast:7 row_mask:0xa bank_mask:0xf
    v_mul_f32 v24, v24, v31
    s_cmp_eq_u32 s3, s33
    v_mov_b32 v26, v4
    v_mov_b32 v16, v24
    s_nop 1
    v_permlane16_swap_b32 v16, v24
    v_add_f32 v24, v24, v16
    v_mov_b32 v16, v24
    s_nop 1
    v_permlane32_swap_b32 v16, v24
    v_add_f32 v24, v24, v16
    s_cbranch_scc1 L_final
    s_mov_b64 exec, 0xffff
    buffer_store_dwordx4 v[24:27], v1, s[36:39], s54 offen sc1
    s_barrier
    s_endpgm
L_final:
    s_barrier
    s_mov_b32 s52, 262144
    v_lshlrev_b32 v9, 16, v9
    s_mov_b64 exec, s[6:7]
    buffer_load_dwordx4 v[96:99], v1, s[36:39], s34 offen offset:0 sc1
L_ysk37:
    s_mov_b64 exec, s[8:9]
    buffer_load_dwordx4 v[100:103], v1, s[36:39], s34 offen offset:1024 sc1
L_ysk38:
    s_mov_b64 exec, s[10:11]
    buffer_load_dwordx4 v[104:107], v1, s[36:39], s34 offen offset:2048 sc1
L_ysk39:
    s_mov_b64 exec, s[14:15]
    buffer_load_dwordx4 v[108:111], v1, s[36:39], s34 offen offset:3072 sc1
L_ysk40:
    s_mov_b64 exec, s[16:17]
    buffer_load_dwordx4 v[112:115], v1, s[36:39], s35 offen offset:0 sc1
L_ysk41:
    s_mov_b64 exec, s[18:19]
    buffer_load_dwordx4 v[116:119], v1, s[36:39], s35 offen offset:1024 sc1
L_ysk42:
    s_mov_b64 exec, s[24:25]
    buffer_load_dwordx4 v[120:123], v1, s[36:39], s35 offen offset:2048 sc1
L_ysk43:
    s_mov_b64 exec, s[30:31]
    buffer_load_dwordx4 v[124:127], v1, s[36:39], s35 offen offset:3072 sc1
L_ysk44:
    s_mov_b64 exec, -1
    s_waitcnt vmcnt(0)
    s_branch L_yc
L_yp:
    s_mov_b64 exec, s[6:7]
    buffer_load_dwordx4 v[96:99], v1, s[36:39], s34 offen offset:0 sc1
L_ysk45:
    s_mov_b64 exec, s[8:9]
    buffer_load_dwordx4 v[100:103], v1, s[36:39], s34 offen offset:1024 sc1
L_ysk46:
    s_mov_b64 exec, s[10:11]
    buffer_load_dwordx4 v[104:107], v1, s[36:39], s34 offen offset:2048 sc1
L_ysk47:
    s_mov_b64 exec, s[14:15]
    buffer_load_dwordx4 v[108:111], v1, s[36:39], s34 offen offset:3072 sc1
L_ysk48:
    s_mov_b64 exec, s[16:17]
    buffer_load_dwordx4 v[112:115], v1, s[36:39], s35 offen offset:0 sc1
L_ysk49:
    s_mov_b64 exec, s[18:19]
    buffer_load_dwordx4 v[116:119], v1, s[36:39], s35 offen offset:1024 sc1
L_ysk50:
    s_mov_b64 exec, s[24:25]
    buffer_load_dwordx4 v[120:123], v1, s[36:39], s35 offen offset:2048 sc1
L_ysk51:
    s_mov_b64 exec, s[30:31]
    buffer_load_dwordx4 v[124:127], v1, s[36:39], s35 offen offset:3072 sc1
L_ysk52:
    s_mov_b64 exec, -1
    s_waitcnt vmcnt(16)
L_yc:
    v_bitop3_b32 v40, v97, v99, s46 bitop3:0x7e
    v_bitop3_b32 v41, v101, v103, s46 bitop3:0x7e
    v_bitop3_b32 v42, v105, v107, s46 bitop3:0x7e
    v_bitop3_b32 v43, v109, v111, s46 bitop3:0x7e
    v_bitop3_b32 v44, v113, v115, s46 bitop3:0x7e
    v_bitop3_b32 v45, v117, v119, s46 bitop3:0x7e
    v_bitop3_b32 v46, v121, v123, s46 bitop3:0x7e
    v_bitop3_b32 v47, v125, v127, s46 bitop3:0x7e
    v_or3_b32 v48, v40, v41, v42
    v_or3_b32 v49, v43, v44, v45
    v_or3_b32 v48, v48, v46, v47
    v_or_b32 v48, v48, v49
    v_cmp_ne_u32 vcc, 0, v48
    s_cbranch_vccz L_yok
    v_cmp_ne_u32 s[6:7], 0, v40
    v_cmp_ne_u32 s[8:9], 0, v41
    v_cmp_ne_u32 s[10:11], 0, v42
    v_cmp_ne_u32 s[14:15], 0, v43
    v_cmp_ne_u32 s[16:17], 0, v44
    v_cmp_ne_u32 s[18:19], 0, v45
    v_cmp_ne_u32 s[24:25], 0, v46
    v_cmp_ne_u32 s[30:31], 0, v47
    s_sub_u32 s52, s52, 1
    s_cbranch_scc0 L_yp
    s_branch L_fail
L_yok:
    v_add_f32 v44, v98, v102
    v_add_f32 v45, v106, v110
    v_add_f32 v46, v114, v118
    v_add_f32 v47, v122, v126
    v_add_f32 v40, v96, v100
    v_add_f32 v41, v104, v108
    v_add_f32 v42, v112, v116
    v_add_f32 v43, v120, v124
    v_add_f32 v44, v44, v45
    v_add_f32 v46, v46, v47
    v_add_f32 v40, v40, v41
    v_add_f32 v42, v42, v43
    v_add_f32 v44, v44, v46
    v_add_f32 v40, v40, v42
    v_mov_b32 v45, v44
    v_mov_b32 v41, v40
    s_nop 0
    v_permlane16_swap_b32 v45, v44
    v_permlane16_swap_b32 v41, v40
    v_add_f32 v44, v44, v45
    v_add_f32 v40, v40, v41
    v_mov_b32 v45, v44
    v_mov_b32 v41, v40
    s_nop 0
    v_permlane32_swap_b32 v45, v44
    v_permlane32_swap_b32 v41, v40
    v_add_f32 v44, v44, v45
    v_add_f32 v40, v40, v41
    v_add_f32 v26, v26, v44
    v_add_f32 v24, v24, v40
    v_cvt_pk_bf16_f32 v24, v24, v26
    v_and_b32 v26, 0xffff0000, v24
    v_mul_f32 v20, 0xbfb8aa3b, v26
    v_exp_f32 v20, v20
    v_lshlrev_b32 v24, 16, v24
    v_add_f32 v20, 1.0, v20
    v_rcp_f32 v20, v20
    s_mov_b64 exec, 0xffff
    v_mul_f32 v26, v26, v20
    v_cvt_pk_bf16_f32 v26, v26, v26
    v_and_b32 v26, 0xffff0000, v26
    v_mul_f32 v24, v24, v26
    v_cvt_pk_bf16_f32 v24, v24, v24
    v_and_b32 v24, 0xffff0000, v24
    v_add_f32 v24, v24, v9
    v_cvt_pk_bf16_f32 v24, v24, v24
    global_store_short v8, v24, s[22:23]
    s_cmp_lg_u32 s53, 0
    s_cbranch_scc1 L_auxst
    v_mov_b32 v24, s46
    s_mov_b64 exec, 1
    global_store_dword v3, v24, s[26:27]
L_auxst:
L_fail:
L_end:
    s_endpgm
L_sl5:
    buffer_store_dwordx4 v[24:27], v18, s[36:39], s48 offen sc1
    s_branch L_dn6
L_qslow:
    s_mov_b64 exec, s[56:57]
    buffer_store_dwordx4 v[24:27], v29, s[36:39], s54 offen sc1
    s_mov_b64 exec, -1
    buffer_load_dwordx4 v[32:35], v1, s[36:39], s48 offen offset:0 sc1
    buffer_load_dwordx4 v[36:39], v1, s[36:39], s48 offen offset:1024 sc1
    buffer_load_dwordx4 v[40:43], v1, s[36:39], s48 offen offset:2048 sc1
    buffer_load_dwordx4 v[44:47], v1, s[36:39], s48 offen offset:3072 sc1
    s_branch L_qc
L_ls18:
    buffer_load_dwordx4 v[96:99], v1, s[36:39], s48 offen offset:0 sc1
    buffer_load_dwordx4 v[100:103], v1, s[36:39], s48 offen offset:1024 sc1
    buffer_load_dwordx4 v[104:107], v1, s[36:39], s48 offen offset:2048 sc1
    buffer_load_dwordx4 v[108:111], v1, s[36:39], s48 offen offset:3072 sc1
    s_branch L_lc19
L_sl21:
    buffer_store_dwordx2 v[24:25], v29, s[36:39], s54 offen sc1
    s_branch L_dn22
L_ls26:
    buffer_load_dwordx2 v[32:33], v16, s[36:39], s48 offen sc1
    s_branch L_lc27
L_h1s:
    buffer_load_dwordx4 v[32:35], v1, s[36:39], s48 offen offset:0 sc1
    buffer_load_dwordx4 v[36:39], v1, s[36:39], s48 offen offset:1024 sc1
    buffer_load_dwordx4 v[40:43], v1, s[36:39], s48 offen offset:2048 sc1
    buffer_load_dwordx4 v[44:47], v1, s[36:39], s48 offen offset:3072 sc1
    buffer_load_dwordx4 v[48:51], v13, s[36:39], s47 offen sc1
    s_branch L_h1c
    s_endpgm
L_code_end:
    s_endpgm
.section .rodata,"a"
.p2align 6
.amdhsa_kernel recurrent_scan__sliding_block_cached__geglu_ffn__decode_kernel
  .amdhsa_next_free_vgpr 168
  .amdhsa_next_free_sgpr 96
  .amdhsa_accum_offset 168
  .amdhsa_group_segment_fixed_size 0
  .amdhsa_kernarg_size 96
  .amdhsa_user_sgpr_count 2
  .amdhsa_user_sgpr_kernarg_segment_ptr 1
  .amdhsa_system_sgpr_workgroup_id_x 1
.end_amdhsa_kernel
```
